```python
import torch

def _softmax(x, axis=-1):
    return torch.softmax(x, dim=axis)
def _gelu(x):
    return torch.nn.functional.gelu(x, approximate="tanh")
def _silu(x):
    return torch.nn.functional.silu(x)
def _sigmoid(x):
    return torch.sigmoid(x)
def _layernorm(x, axis=-1, eps=1e-5):
    m = x.mean(dim=axis, keepdim=True)
    v = x.var(dim=axis, keepdim=True, unbiased=False)
    return (x - m) / torch.sqrt(v + eps)
def _scatter_add(tgt, idx, src, axis=0):
    return tgt.clone().index_add_(axis, idx, src)
def _segment_sum(src, seg, n):
    out = torch.zeros((n,) + src.shape[1:], dtype=src.dtype)
    return out.index_add_(0, seg, src)
def _pad(x, pw):
    flat = tuple(v for pair in reversed(pw) for v in pair)
    return torch.nn.functional.pad(x, flat)

kernel_name = 'parallel_sum__ssm_conv_s4d__glu_gated_reglu__prompt'

def setup_inputs():

    _w = (lambda a: (lambda t: t.to(torch.bfloat16) if t.is_floating_point() else t)(torch.as_tensor(a)))
    def _A_setup():
        Bsz, L, D, N = 1, 2048, 512, 128
        return {
            "u": _w((lambda *s: torch.randn(*s, dtype=torch.bfloat16) * 0.05)(Bsz, L, D)),
            "log_A_real": _w((lambda *s: torch.randn(*s, dtype=torch.bfloat16) * 3.2)(D, N) * 0.5),
            "A_imag": _w((lambda *s: torch.randn(*s, dtype=torch.bfloat16) * 0.05)(D, N) * 3.14),
            "C_real": _w((lambda *s: torch.randn(*s, dtype=torch.bfloat16) * 0.1)(D, N) / N ** 0.5),
            "C_imag": _w((lambda *s: torch.randn(*s, dtype=torch.bfloat16) * 0.2)(D, N) / N ** 0.5),
            "log_dt": _w((lambda *s: torch.randn(*s, dtype=torch.bfloat16) * 0.05)(D) * 0.5 - 4.0),
            "D_skip": _w((lambda *s: torch.randn(*s, dtype=torch.bfloat16) * 0.05)(D)),
        }
    _A_in = _A_setup()

    def _B_setup():
        B, S, D, F = 1, 2048, 512, 1376
        return {
            "x": _w((lambda *s: torch.randn(*s, dtype=torch.bfloat16) * 0.05)(B, S, D)),
            "W_gate": _w((lambda *s: torch.randn(*s, dtype=torch.bfloat16) * 0.4)(D, F) * (2.0 / D) ** 0.5),
            "W_up": _w((lambda *s: torch.randn(*s, dtype=torch.bfloat16) * 0.4)(D, F) * (2.0 / D) ** 0.5),
            "W_down": _w((lambda *s: torch.randn(*s, dtype=torch.bfloat16) * 0.4)(F, D) * (1.0 / F) ** 0.5),
        }
    _B_in = _B_setup()

    return {
        "A_u": _A_in["u"],
        "A_log_A_real": _A_in["log_A_real"],
        "A_A_imag": _A_in["A_imag"],
        "A_C_real": _A_in["C_real"],
        "A_C_imag": _A_in["C_imag"],
        "A_log_dt": _A_in["log_dt"],
        "A_D_skip": _A_in["D_skip"],
        "B_x": _B_in["x"],
        "B_W_gate": _B_in["W_gate"],
        "B_W_up": _B_in["W_up"],
        "B_W_down": _B_in["W_down"],
    }

def reference(A_u, A_log_A_real, A_A_imag, A_C_real, A_C_imag, A_log_dt, A_D_skip, B_x, B_W_gate, B_W_up, B_W_down):
    def _A_ref(u, log_A_real, A_imag, C_real, C_imag, log_dt, D_skip):
        L = u.shape[1]
        dt = torch.exp(log_dt)
        A = -torch.exp(log_A_real) + 1j * A_imag
        C = (C_real + 1j * C_imag) * dt[:, None]
        pos = (lambda x, dt: x.to(dt))(torch.arange(L), log_dt.dtype)
        P = torch.exp((A * dt[:, None])[:, :, None] * pos[None, None, :])
        K = 2.0 * torch.einsum("dn,dnl->dl", C, P).real
        L2 = 2 * L
        u_t = (lambda x, *d: x.permute(*d))(u, 0, 2, 1)
        Kf = (lambda x, *a, **k: torch.fft.rfft(x.float(), *a, **k))(K, L2)
        Uf = (lambda x, *a, **k: torch.fft.rfft(x.float(), *a, **k))(u_t, L2)
        y = (lambda x, *a, **k: torch.fft.irfft(x, *a, **k).to(torch.bfloat16))(Uf * Kf[None, :, :], L2)[:, :, :L]
        y = (lambda x, *d: x.permute(*d))(y, 0, 2, 1)
        return y + u * D_skip[None, None, :]

    def _B_ref(x, W_gate, W_up, W_down):
        gate = torch.einsum("bsd,df->bsf", x, W_gate)
        up = torch.einsum("bsd,df->bsf", x, W_up)
        gate = gate * (lambda x, dt: x.to(dt))(gate > 0, gate.dtype)
        h = gate * up
        return torch.einsum("bsf,fd->bsd", h, W_down)

    x = A_u
    xn = _layernorm(x, axis=-1)
    return x + _A_ref(xn, A_log_A_real, A_A_imag, A_C_real, A_C_imag, A_log_dt, A_D_skip) + _B_ref(xn, B_W_gate, B_W_up, B_W_down)
```

```asm
; @launch grid=(256,1,1) block=(512,1,1) lds=159744
.amdgcn_target "amdgcn-amd-amdhsa--gfx950"
.text
.globl parallel_sum__ssm_conv_s4d__glu_gated_reglu__prompt_kernel
.p2align 8
.type parallel_sum__ssm_conv_s4d__glu_gated_reglu__prompt_kernel,@function
parallel_sum__ssm_conv_s4d__glu_gated_reglu__prompt_kernel:
    s_cmp_ge_u32 s2, 256
    s_cbranch_scc1 KF_END
    s_load_dwordx16 s[16:31], s[0:1], 0
    s_load_dwordx8 s[32:39], s[0:1], 64
    s_load_dwordx4 s[80:83], s[0:1], 96
    v_lshrrev_b32 v1, 6, v0
    v_and_b32 v2, 63, v0
    v_readfirstlane_b32 s42, v1
    s_and_b32 s3, s2, 1
    s_lshl_b32 s40, s3, 3
    s_bfe_u32 s3, s2, 0x30003
    s_add_u32 s40, s40, s3
    s_bfe_u32 s41, s2, 0x20001
    s_lshl_b32 s41, s41, 2
    s_lshr_b32 s3, s2, 6
    s_add_u32 s41, s41, s3
    s_and_b32 s78, s2, 7
    s_lshl_b32 s78, s78, 2
    s_bfe_u32 s3, s2, 0x20003
    s_add_u32 s78, s78, s3
    s_lshr_b32 s79, s2, 5
    v_and_b32 v3, 15, v2
    v_lshrrev_b32 v4, 4, v2
    v_mov_b32 v246, 154368
    v_mov_b32 v247, 1
    v_mov_b32 v5, 0
    v_lshl_add_u32 v6, v3, 2, v246
    ds_write_b32 v6, v5
    s_cmp_ge_u32 s42, 4
    s_cbranch_scc1 KF_SIDE
    s_mul_i32 s43, s41, 3
    s_min_u32 s43, s43, 40
    s_lshr_b32 s71, s42, 1
    s_and_b32 s72, s42, 1
    v_lshrrev_b32 v5, 3, v2
    v_and_b32 v6, 7, v2
    v_xor_b32 v6, v6, v4
    s_lshl_b32 s3, s40, 7
    s_lshl_b32 s55, s42, 5
    s_add_u32 s3, s3, s55
    v_add_u32 v5, s3, v5
    v_lshlrev_b32 v5, 10, v5
    v_lshl_add_u32 v8, v6, 4, v5
    v_xor_b32 v6, 4, v6
    v_lshl_add_u32 v9, v6, 4, v5
    v_add_u32 v9, 7168, v9
    v_add_u32 v10, 14336, v8
    v_add_u32 v11, 14336, v9
    s_mul_i32 s3, s72, 44032
    s_lshl_b32 s55, s43, 6
    s_add_u32 s3, s3, s55
    v_lshrrev_b32 v5, 2, v2
    v_and_b32 v6, 3, v2
    v_add_u32 v7, 0, v5
    v_mul_u32_u24 v26, 43, v7
    v_lshrrev_b32 v26, 7, v26
    v_mul_u32_u24 v27, 3, v26
    v_sub_u32 v7, v7, v27
    v_lshrrev_b32 v27, 2, v26
    v_and_b32 v27, 2, v27
    v_xor_b32 v27, v27, v6
    v_mul_u32_u24 v26, 2752, v26
    v_lshl_add_u32 v26, v7, 6, v26
    v_lshl_add_u32 v26, v27, 4, v26
    v_add_u32 v26, s3, v26
    v_subrev_u32 v12, 0, v26
    v_add_u32 v7, 16, v5
    v_mul_u32_u24 v26, 43, v7
    v_lshrrev_b32 v26, 7, v26
    v_mul_u32_u24 v27, 3, v26
    v_sub_u32 v7, v7, v27
    v_lshrrev_b32 v27, 2, v26
    v_and_b32 v27, 2, v27
    v_xor_b32 v27, v27, v6
    v_mul_u32_u24 v26, 2752, v26
    v_lshl_add_u32 v26, v7, 6, v26
    v_lshl_add_u32 v26, v27, 4, v26
    v_add_u32 v26, s3, v26
    v_subrev_u32 v13, 1024, v26
    v_add_u32 v7, 32, v5
    v_mul_u32_u24 v26, 43, v7
    v_lshrrev_b32 v26, 7, v26
    v_mul_u32_u24 v27, 3, v26
    v_sub_u32 v7, v7, v27
    v_lshrrev_b32 v27, 2, v26
    v_and_b32 v27, 2, v27
    v_xor_b32 v27, v27, v6
    v_mul_u32_u24 v26, 2752, v26
    v_lshl_add_u32 v26, v7, 6, v26
    v_lshl_add_u32 v26, v27, 4, v26
    v_add_u32 v26, s3, v26
    v_subrev_u32 v14, 2048, v26
    s_lshl_b32 s53, s42, 12
    s_mul_i32 s54, s42, 3072
    s_add_u32 s54, s54, 49152
    s_and_b32 s3, s41, 3
    s_lshl_b32 s3, s3, 1
    s_add_u32 s3, s3, s40
    s_and_b32 s3, s3, 7
    s_lshl_b32 s51, s3, 7
    s_mul_i32 s52, s3, 176128
    s_waitcnt lgkmcnt(0)
    s_mov_b64 s[4:5], s[16:17]
    s_mov_b32 s6, 2097152
    s_mov_b32 s7, 0x00020000
    s_cmp_ge_u32 s42, 2
    s_cselect_b32 s8, s34, s32
    s_cselect_b32 s9, s35, s33
    s_and_b32 s9, s9, 0xffff
    s_mov_b32 s10, 1409024
    s_mov_b32 s11, 0x00020000
    s_mov_b64 s[12:13], s[82:83]
    s_mov_b32 s14, 23068672
    s_mov_b32 s15, 0x00020000
    s_mul_i32 s3, s42, 11
    v_min_u32 v6, 10, v3
    v_add_u32 v6, s3, v6
    v_min_u32 v6, 42, v6
    s_lshr_b32 s3, s79, 1
    v_lshl_add_u32 v236, v6, 2, s3
    v_lshlrev_b32 v236, 7, v236
    v_mul_u32_u24 v6, 43, v6
    v_lshrrev_b32 v6, 7, v6
    s_lshr_b32 s3, s78, 1
    s_lshl_b32 s3, s3, 4
    v_add_lshl_u32 v237, v6, s3, 7
    s_mov_b32 s59, 16908288
    s_cmp_lt_u32 s41, 15
    s_cbranch_scc1 G1_GO
    s_barrier
    v_mov_b32 v5, 10
    s_mov_b64 exec, 1
    ds_add_u32 v246, v5 offset:0
    s_mov_b64 exec, -1
    s_mov_b32 s63, 0
G1_PT2:
    s_sleep 8
    ds_read_b32 v248, v246 offset:52
    s_add_u32 s63, s63, 1
    s_waitcnt lgkmcnt(0)
    v_readfirstlane_b32 s62, v248
    s_lshr_b32 s97, s63, 22
    s_lshl_b32 s97, s97, 8
    s_add_u32 s62, s62, s97
    s_cmp_lt_u32 s62, 1
    s_cbranch_scc1 G1_PT2
    v_mov_b32 v7, 154432
    ds_read_b64 v[8:9], v7
    v_mov_b32 v238, 0
    v_mov_b32 v239, 0
    s_waitcnt lgkmcnt(0)
    v_readfirstlane_b32 s76, v8
    v_readfirstlane_b32 s77, v9
    s_branch G2_START
G1_GO:
    s_add_u32 m0, 0, s53
    s_nop 0
    buffer_load_dwordx4 v8, s[4:7], s51 offen offset:0 lds
    buffer_load_dwordx4 v9, s[4:7], s51 offen offset:1024 lds
    buffer_load_dwordx4 v10, s[4:7], s51 offen offset:2048 lds
    buffer_load_dwordx4 v11, s[4:7], s51 offen offset:3072 lds
    s_add_u32 s51, s51, 128
    s_and_b32 s51, s51, 1023
    s_add_u32 m0, 0, s54
    s_nop 0
    buffer_load_dwordx4 v12, s[8:11], s52 offen offset:0 lds
    buffer_load_dwordx4 v13, s[8:11], s52 offen offset:1024 lds
    buffer_load_dwordx4 v14, s[8:11], s52 offen offset:2048 lds
    s_add_u32 s52, s52, 88064
    s_cmp_eq_u32 s52, 1409024
    s_cselect_b32 s52, 0, s52
    s_add_u32 m0, 12288, s54
    s_nop 0
    buffer_load_dwordx4 v12, s[8:11], s52 offen offset:0 lds
    buffer_load_dwordx4 v13, s[8:11], s52 offen offset:1024 lds
    buffer_load_dwordx4 v14, s[8:11], s52 offen offset:2048 lds
    s_add_u32 s52, s52, 88064
    s_cmp_eq_u32 s52, 1409024
    s_cselect_b32 s52, 0, s52
    s_add_u32 m0, 16384, s53
    s_nop 0
    buffer_load_dwordx4 v8, s[4:7], s51 offen offset:0 lds
    buffer_load_dwordx4 v9, s[4:7], s51 offen offset:1024 lds
    buffer_load_dwordx4 v10, s[4:7], s51 offen offset:2048 lds
    buffer_load_dwordx4 v11, s[4:7], s51 offen offset:3072 lds
    s_add_u32 s51, s51, 128
    s_and_b32 s51, s51, 1023
    s_barrier
    s_lshl_b32 s3, s40, 1
    s_add_u32 s3, s3, s71
    s_mul_i32 s3, s3, 43
    s_add_u32 s3, s3, s43
    s_lshl_b32 s3, s3, 12
    s_lshl_b32 s73, s72, 13
    s_add_u32 s73, s73, s3
    s_lshl_b32 s74, s72, 11
    s_add_u32 s74, s74, s3
    s_add_u32 s74, s74, 4096
    s_cmp_eq_u32 s41, 14
    s_cselect_b32 s3, 0x7f000000, 0
    s_or_b32 s74, s74, s3
    s_cmp_eq_u32 s72, 0
    s_cselect_b32 s3, s3, 0
    s_or_b32 s73, s73, s3
    v_lshlrev_b32 v27, 4, v2
    s_lshl_b32 s3, s40, 10
    s_lshl_b32 s75, s71, 9
    s_add_u32 s75, s75, s3
    s_add_u32 s75, s75, 16777216
    v_lshrrev_b32 v26, 1, v3
    v_lshlrev_b32 v26, 4, v26
    v_lshrrev_b32 v5, 1, v3
    v_xor_b32 v5, v5, v4
    v_lshlrev_b32 v6, 7, v3
    v_lshl_add_u32 v5, v5, 4, v6
    s_lshl_b32 s3, s71, 13
    v_add_u32 v16, s3, v5
    v_add_u32 v17, 0x1000, v16
    v_xor_b32 v18, 64, v16
    v_xor_b32 v19, 64, v17
    v_bfe_u32 v5, v2, 2, 2
    v_lshl_add_u32 v5, v4, 3, v5
    v_mul_u32_u24 v5, 192, v5
    v_and_b32 v6, 1, v2
    v_lshl_add_u32 v5, v6, 3, v5
    v_bfe_u32 v6, v2, 1, 1
    v_and_b32 v7, 1, v4
    v_lshl_add_u32 v6, v7, 1, v6
    v_lshl_add_u32 v5, v6, 4, v5
    s_mul_i32 s55, s71, 6144
    s_mul_i32 s56, s72, 3
    s_add_u32 s3, s56, 0
    s_and_b32 s57, s3, 1
    s_lshl_b32 s57, s57, 5
    s_lshr_b32 s3, s3, 1
    s_lshl_b32 s3, s3, 6
    s_add_u32 s3, s3, 49152
    v_xor_b32 v6, s57, v5
    s_add_u32 s57, s3, s55
    v_add_u32 v20, s57, v6
    s_sub_u32 s57, s3, s55
    s_add_u32 s57, s57, 6144
    v_add_u32 v23, s57, v6
    s_add_u32 s3, s56, 1
    s_and_b32 s57, s3, 1
    s_lshl_b32 s57, s57, 5
    s_lshr_b32 s3, s3, 1
    s_lshl_b32 s3, s3, 6
    s_add_u32 s3, s3, 49152
    v_xor_b32 v6, s57, v5
    s_add_u32 s57, s3, s55
    v_add_u32 v21, s57, v6
    s_sub_u32 s57, s3, s55
    s_add_u32 s57, s57, 6144
    v_add_u32 v24, s57, v6
    s_add_u32 s3, s56, 2
    s_and_b32 s57, s3, 1
    s_lshl_b32 s57, s57, 5
    s_lshr_b32 s3, s3, 1
    s_lshl_b32 s3, s3, 6
    s_add_u32 s3, s3, 49152
    v_xor_b32 v6, s57, v5
    s_add_u32 s57, s3, s55
    v_add_u32 v22, s57, v6
    s_sub_u32 s57, s3, s55
    s_add_u32 s57, s57, 6144
    v_add_u32 v25, s57, v6
    v_mov_b32 v28, 0x3f803f80
    v_mov_b32 v29, 0x3f803f80
    v_mov_b32 v30, 0x3f803f80
    v_mov_b32 v31, 0x3f803f80
    v_mov_b32 v6, 0
    v_mov_b32 v7, 0
    v_pk_mov_b32 v[80:81], v[6:7], v[6:7]
    v_pk_mov_b32 v[82:83], v[6:7], v[6:7]
    v_pk_mov_b32 v[84:85], v[6:7], v[6:7]
    v_pk_mov_b32 v[86:87], v[6:7], v[6:7]
    v_pk_mov_b32 v[88:89], v[6:7], v[6:7]
    v_pk_mov_b32 v[90:91], v[6:7], v[6:7]
    v_pk_mov_b32 v[92:93], v[6:7], v[6:7]
    v_pk_mov_b32 v[94:95], v[6:7], v[6:7]
    v_pk_mov_b32 v[96:97], v[6:7], v[6:7]
    v_pk_mov_b32 v[98:99], v[6:7], v[6:7]
    v_pk_mov_b32 v[100:101], v[6:7], v[6:7]
    v_pk_mov_b32 v[102:103], v[6:7], v[6:7]
    v_pk_mov_b32 v[104:105], v[6:7], v[6:7]
    v_pk_mov_b32 v[106:107], v[6:7], v[6:7]
    v_pk_mov_b32 v[108:109], v[6:7], v[6:7]
    v_pk_mov_b32 v[110:111], v[6:7], v[6:7]
    v_pk_mov_b32 v[112:113], v[6:7], v[6:7]
    v_pk_mov_b32 v[114:115], v[6:7], v[6:7]
    v_pk_mov_b32 v[116:117], v[6:7], v[6:7]
    v_pk_mov_b32 v[118:119], v[6:7], v[6:7]
    v_pk_mov_b32 v[120:121], v[6:7], v[6:7]
    v_pk_mov_b32 v[122:123], v[6:7], v[6:7]
    v_pk_mov_b32 v[124:125], v[6:7], v[6:7]
    v_pk_mov_b32 v[126:127], v[6:7], v[6:7]
    v_pk_mov_b32 v[128:129], v[6:7], v[6:7]
    v_pk_mov_b32 v[130:131], v[6:7], v[6:7]
    v_pk_mov_b32 v[132:133], v[6:7], v[6:7]
    v_pk_mov_b32 v[134:135], v[6:7], v[6:7]
    v_pk_mov_b32 v[136:137], v[6:7], v[6:7]
    v_pk_mov_b32 v[138:139], v[6:7], v[6:7]
    v_pk_mov_b32 v[140:141], v[6:7], v[6:7]
    v_pk_mov_b32 v[142:143], v[6:7], v[6:7]
    v_pk_mov_b32 v[144:145], v[6:7], v[6:7]
    v_pk_mov_b32 v[146:147], v[6:7], v[6:7]
    v_pk_mov_b32 v[148:149], v[6:7], v[6:7]
    v_pk_mov_b32 v[150:151], v[6:7], v[6:7]
    v_pk_mov_b32 v[152:153], v[6:7], v[6:7]
    v_pk_mov_b32 v[154:155], v[6:7], v[6:7]
    v_pk_mov_b32 v[156:157], v[6:7], v[6:7]
    v_pk_mov_b32 v[158:159], v[6:7], v[6:7]
    v_pk_mov_b32 v[160:161], v[6:7], v[6:7]
    v_pk_mov_b32 v[162:163], v[6:7], v[6:7]
    v_pk_mov_b32 v[164:165], v[6:7], v[6:7]
    v_pk_mov_b32 v[166:167], v[6:7], v[6:7]
    v_pk_mov_b32 v[168:169], v[6:7], v[6:7]
    v_pk_mov_b32 v[170:171], v[6:7], v[6:7]
    v_pk_mov_b32 v[172:173], v[6:7], v[6:7]
    v_pk_mov_b32 v[174:175], v[6:7], v[6:7]
    v_pk_mov_b32 v[176:177], v[6:7], v[6:7]
    v_pk_mov_b32 v[178:179], v[6:7], v[6:7]
    v_pk_mov_b32 v[180:181], v[6:7], v[6:7]
    v_pk_mov_b32 v[182:183], v[6:7], v[6:7]
    v_pk_mov_b32 v[184:185], v[6:7], v[6:7]
    v_pk_mov_b32 v[186:187], v[6:7], v[6:7]
    s_mov_b32 s44, 0
    s_mov_b32 s45, 0
    s_mov_b32 s46, 0
    s_mov_b32 s47, 12288
    s_mov_b32 s64, 32768
    s_mov_b32 s65, 49152
    s_mov_b32 s66, 61440
    s_mov_b32 s67, 4
    v_add_u32 v204, s45, v16
    v_add_u32 v205, s45, v17
    v_add_u32 v208, s46, v20
    v_add_u32 v209, s46, v21
    v_add_u32 v210, s46, v22
    v_add_u32 v211, s46, v23
    v_add_u32 v212, s46, v24
    v_add_u32 v213, s46, v25
    s_waitcnt vmcnt(4)
    s_mov_b64 exec, 1
    ds_add_u32 v246, v247 offset:0
    s_mov_b64 exec, -1
    s_add_u32 m0, 24576, s54
    s_nop 0
    buffer_load_dwordx4 v12, s[8:11], s52 offen offset:0 lds
    buffer_load_dwordx4 v13, s[8:11], s52 offen offset:1024 lds
    buffer_load_dwordx4 v14, s[8:11], s52 offen offset:2048 lds
    s_add_u32 s52, s52, 88064
    s_cmp_eq_u32 s52, 1409024
    s_cselect_b32 s52, 0, s52
    s_add_u32 m0, 36864, s54
    s_nop 0
    buffer_load_dwordx4 v12, s[8:11], s52 offen offset:0 lds
    buffer_load_dwordx4 v13, s[8:11], s52 offen offset:1024 lds
    buffer_load_dwordx4 v14, s[8:11], s52 offen offset:2048 lds
    s_add_u32 s52, s52, 88064
    s_cmp_eq_u32 s52, 1409024
    s_cselect_b32 s52, 0, s52
    s_cmp_ge_u32 s44, 6
    s_cselect_b32 s68, 0x7f000000, s51
    s_cselect_b32 s69, 0x7f000000, s52
    s_mov_b32 s63, 0
G1_P0:
    ds_read_b32 v248, v246 offset:0
    s_add_u32 s63, s63, 1
    s_waitcnt lgkmcnt(0)
    v_readfirstlane_b32 s62, v248
    s_lshr_b32 s97, s63, 22
    s_lshl_b32 s97, s97, 8
    s_add_u32 s62, s62, s97
    s_cmp_lt_u32 s62, s67
    s_cbranch_scc1 G1_P0
    s_setprio 3
    ds_read_b128 v[32:35], v204 offset:0
    ds_read_b128 v[36:39], v204 offset:2048
    ds_read_b128 v[40:43], v205 offset:0
    ds_read_b128 v[44:47], v205 offset:2048
    ds_read_b64_tr_b16 v[64:65], v208
    ds_read_b64_tr_b16 v[66:67], v208 offset:768
    ds_read_b64_tr_b16 v[68:69], v209
    ds_read_b64_tr_b16 v[70:71], v209 offset:768
G1_LOOP:
    ds_read_b64_tr_b16 v[72:73], v210
    ds_read_b64_tr_b16 v[74:75], v210 offset:768
    s_cmp_lg_u32 s44, 7
    s_cbranch_scc1 G1_NS
    buffer_load_dwordx4 v[220:223], v26, s[12:15], s75 offen offset:0 sc1
    buffer_load_dwordx4 v[224:227], v26, s[12:15], s75 offen offset:128 sc1
    buffer_load_dwordx4 v[228:231], v26, s[12:15], s75 offen offset:256 sc1
    buffer_load_dwordx4 v[232:235], v26, s[12:15], s75 offen offset:384 sc1
    buffer_load_dwordx2 v[238:239], v236, s[12:15], s59 offen sc1
G1_NS:
    s_waitcnt lgkmcnt(4)
    v_mfma_f32_16x16x32_bf16 v[80:83], v[64:67], v[32:35], v[80:83]
    v_add_u32 v206, s45, v18
    v_add_u32 v207, s45, v19
    v_add_u32 v214, s47, v20
    v_mfma_f32_16x16x32_bf16 v[84:87], v[64:67], v[36:39], v[84:87]
    v_add_u32 v215, s47, v21
    v_add_u32 v216, s47, v22
    v_add_u32 v217, s47, v23
    v_mfma_f32_16x16x32_bf16 v[88:91], v[64:67], v[40:43], v[88:91]
    v_add_u32 v218, s47, v24
    v_add_u32 v219, s47, v25
    s_add_u32 s51, s51, 128
    v_mfma_f32_16x16x32_bf16 v[92:95], v[64:67], v[44:47], v[92:95]
    ds_read_b64_tr_b16 v[76:77], v211
    ds_read_b64_tr_b16 v[78:79], v211 offset:768
    v_mfma_f32_16x16x32_bf16 v[176:179], v[64:67], v[28:31], v[176:179]
    s_and_b32 s51, s51, 1023
    s_add_u32 s52, s52, 88064
    s_cmp_eq_u32 s52, 1409024
    s_cselect_b32 s52, 0, s52
    s_waitcnt lgkmcnt(4)
    v_mfma_f32_16x16x32_bf16 v[96:99], v[68:71], v[32:35], v[96:99]
    ds_read_b64_tr_b16 v[188:189], v212
    ds_read_b64_tr_b16 v[190:191], v212 offset:768
    v_mfma_f32_16x16x32_bf16 v[100:103], v[68:71], v[36:39], v[100:103]
    s_add_u32 m0, s64, s53
    s_nop 0
    buffer_load_dwordx4 v8, s[4:7], s68 offen offset:0 lds
    v_mfma_f32_16x16x32_bf16 v[104:107], v[68:71], v[40:43], v[104:107]
    s_cmp_ge_u32 s44, 6
    s_cselect_b32 s70, 0x7f000000, s52
    s_add_u32 s52, s52, 88064
    v_mfma_f32_16x16x32_bf16 v[108:111], v[68:71], v[44:47], v[108:111]
    buffer_load_dwordx4 v9, s[4:7], s68 offen offset:1024 lds
    v_mfma_f32_16x16x32_bf16 v[180:183], v[68:71], v[28:31], v[180:183]
    s_cmp_eq_u32 s52, 1409024
    s_cselect_b32 s52, 0, s52
    s_waitcnt lgkmcnt(4)
    v_mfma_f32_16x16x32_bf16 v[112:115], v[72:75], v[32:35], v[112:115]
    ds_read_b64_tr_b16 v[192:193], v213
    ds_read_b64_tr_b16 v[194:195], v213 offset:768
    v_mfma_f32_16x16x32_bf16 v[116:119], v[72:75], v[36:39], v[116:119]
    buffer_load_dwordx4 v10, s[4:7], s68 offen offset:2048 lds
    v_mfma_f32_16x16x32_bf16 v[120:123], v[72:75], v[40:43], v[120:123]
    ds_read_b128 v[48:51], v206 offset:0
    ds_read_b128 v[52:55], v206 offset:2048
    ds_read_b128 v[56:59], v207 offset:0
    ds_read_b128 v[60:63], v207 offset:2048
    v_mfma_f32_16x16x32_bf16 v[124:127], v[72:75], v[44:47], v[124:127]
    buffer_load_dwordx4 v11, s[4:7], s68 offen offset:3072 lds
    v_mfma_f32_16x16x32_bf16 v[184:187], v[72:75], v[28:31], v[184:187]
    s_waitcnt lgkmcnt(8)
    v_mfma_f32_16x16x32_bf16 v[128:131], v[76:79], v[32:35], v[128:131]
    ds_read_b64_tr_b16 v[196:197], v214
    ds_read_b64_tr_b16 v[198:199], v214 offset:768
    v_mfma_f32_16x16x32_bf16 v[132:135], v[76:79], v[36:39], v[132:135]
    s_add_u32 m0, s65, s54
    s_nop 0
    buffer_load_dwordx4 v12, s[8:11], s69 offen offset:0 lds
    v_mfma_f32_16x16x32_bf16 v[136:139], v[76:79], v[40:43], v[136:139]
    v_mfma_f32_16x16x32_bf16 v[140:143], v[76:79], v[44:47], v[140:143]
    s_waitcnt lgkmcnt(8)
    v_mfma_f32_16x16x32_bf16 v[144:147], v[188:191], v[32:35], v[144:147]
    ds_read_b64_tr_b16 v[200:201], v215
    ds_read_b64_tr_b16 v[202:203], v215 offset:768
    v_mfma_f32_16x16x32_bf16 v[148:151], v[188:191], v[36:39], v[148:151]
    buffer_load_dwordx4 v13, s[8:11], s69 offen offset:1024 lds
    v_mfma_f32_16x16x32_bf16 v[152:155], v[188:191], v[40:43], v[152:155]
    v_mfma_f32_16x16x32_bf16 v[156:159], v[188:191], v[44:47], v[156:159]
    s_waitcnt lgkmcnt(8)
    v_mfma_f32_16x16x32_bf16 v[160:163], v[192:195], v[32:35], v[160:163]
    ds_read_b64_tr_b16 v[64:65], v216
    ds_read_b64_tr_b16 v[66:67], v216 offset:768
    v_mfma_f32_16x16x32_bf16 v[164:167], v[192:195], v[36:39], v[164:167]
    buffer_load_dwordx4 v14, s[8:11], s69 offen offset:2048 lds
    v_mfma_f32_16x16x32_bf16 v[168:171], v[192:195], v[40:43], v[168:171]
    v_mfma_f32_16x16x32_bf16 v[172:175], v[192:195], v[44:47], v[172:175]
    s_waitcnt lgkmcnt(4)
    v_mfma_f32_16x16x32_bf16 v[80:83], v[196:199], v[48:51], v[80:83]
    ds_read_b64_tr_b16 v[68:69], v217
    ds_read_b64_tr_b16 v[70:71], v217 offset:768
    v_mfma_f32_16x16x32_bf16 v[84:87], v[196:199], v[52:55], v[84:87]
    s_add_u32 m0, s66, s54
    s_nop 0
    buffer_load_dwordx4 v12, s[8:11], s70 offen offset:0 lds
    v_mfma_f32_16x16x32_bf16 v[88:91], v[196:199], v[56:59], v[88:91]
    v_mfma_f32_16x16x32_bf16 v[92:95], v[196:199], v[60:63], v[92:95]
    v_mfma_f32_16x16x32_bf16 v[176:179], v[196:199], v[28:31], v[176:179]
    s_waitcnt lgkmcnt(4)
    v_mfma_f32_16x16x32_bf16 v[96:99], v[200:203], v[48:51], v[96:99]
    ds_read_b64_tr_b16 v[72:73], v218
    ds_read_b64_tr_b16 v[74:75], v218 offset:768
    v_mfma_f32_16x16x32_bf16 v[100:103], v[200:203], v[52:55], v[100:103]
    buffer_load_dwordx4 v13, s[8:11], s70 offen offset:1024 lds
    v_mfma_f32_16x16x32_bf16 v[104:107], v[200:203], v[56:59], v[104:107]
    v_mfma_f32_16x16x32_bf16 v[108:111], v[200:203], v[60:63], v[108:111]
    v_mfma_f32_16x16x32_bf16 v[180:183], v[200:203], v[28:31], v[180:183]
    s_waitcnt lgkmcnt(4)
    v_mfma_f32_16x16x32_bf16 v[112:115], v[64:67], v[48:51], v[112:115]
    ds_read_b64_tr_b16 v[76:77], v219
    ds_read_b64_tr_b16 v[78:79], v219 offset:768
    v_mfma_f32_16x16x32_bf16 v[116:119], v[64:67], v[52:55], v[116:119]
    buffer_load_dwordx4 v14, s[8:11], s70 offen offset:2048 lds
    v_mfma_f32_16x16x32_bf16 v[120:123], v[64:67], v[56:59], v[120:123]
    v_mfma_f32_16x16x32_bf16 v[124:127], v[64:67], v[60:63], v[124:127]
    v_mfma_f32_16x16x32_bf16 v[184:187], v[64:67], v[28:31], v[184:187]
    s_waitcnt lgkmcnt(0)
    s_waitcnt vmcnt(10)
    s_mov_b64 exec, 1
    ds_add_u32 v246, v247 offset:0
    s_mov_b64 exec, -1
    v_mfma_f32_16x16x32_bf16 v[128:131], v[68:71], v[48:51], v[128:131]
    s_mov_b32 s64, s45
    s_mov_b32 s65, s46
    s_mov_b32 s66, s47
    v_mfma_f32_16x16x32_bf16 v[132:135], v[68:71], v[52:55], v[132:135]
    s_add_u32 s45, s45, 16384
    s_cmp_eq_u32 s45, 49152
    s_cselect_b32 s45, 0, s45
    v_mfma_f32_16x16x32_bf16 v[136:139], v[68:71], v[56:59], v[136:139]
    s_add_u32 s46, s47, 12288
    s_cmp_eq_u32 s46, 73728
    s_cselect_b32 s46, 0, s46
    v_mfma_f32_16x16x32_bf16 v[140:143], v[68:71], v[60:63], v[140:143]
    v_add_u32 v204, s45, v16
    v_add_u32 v205, s45, v17
    v_add_u32 v208, s46, v20
    v_mfma_f32_16x16x32_bf16 v[144:147], v[72:75], v[48:51], v[144:147]
    v_add_u32 v209, s46, v21
    v_add_u32 v210, s46, v22
    v_add_u32 v211, s46, v23
    v_mfma_f32_16x16x32_bf16 v[148:151], v[72:75], v[52:55], v[148:151]
    ds_read_b32 v248, v246 offset:0
    v_add_u32 v212, s46, v24
    v_add_u32 v213, s46, v25
    s_add_u32 s47, s46, 12288
    v_mfma_f32_16x16x32_bf16 v[152:155], v[72:75], v[56:59], v[152:155]
    s_cmp_eq_u32 s47, 73728
    s_cselect_b32 s47, 0, s47
    s_add_u32 s67, s67, 4
    v_mfma_f32_16x16x32_bf16 v[156:159], v[72:75], v[60:63], v[156:159]
    s_add_u32 s44, s44, 1
    s_waitcnt lgkmcnt(0)
    v_readfirstlane_b32 s62, v248
    s_nop 1
    s_cmp_ge_u32 s62, s67
    s_cbranch_scc1 G1_CONT
    s_mov_b32 s63, 0
G1_P1:
    ds_read_b32 v248, v246 offset:0
    s_add_u32 s63, s63, 1
    s_waitcnt lgkmcnt(0)
    v_readfirstlane_b32 s62, v248
    s_lshr_b32 s97, s63, 22
    s_lshl_b32 s97, s97, 8
    s_add_u32 s62, s62, s97
    s_cmp_lt_u32 s62, s67
    s_cbranch_scc1 G1_P1
G1_CONT:
    ds_read_b128 v[32:35], v204 offset:0
    ds_read_b128 v[36:39], v204 offset:2048
    ds_read_b128 v[40:43], v205 offset:0
    ds_read_b128 v[44:47], v205 offset:2048
    v_mfma_f32_16x16x32_bf16 v[160:163], v[76:79], v[48:51], v[160:163]
    ds_read_b64_tr_b16 v[64:65], v208
    ds_read_b64_tr_b16 v[66:67], v208 offset:768
    v_mfma_f32_16x16x32_bf16 v[164:167], v[76:79], v[52:55], v[164:167]
    ds_read_b64_tr_b16 v[68:69], v209
    ds_read_b64_tr_b16 v[70:71], v209 offset:768
    v_mfma_f32_16x16x32_bf16 v[168:171], v[76:79], v[56:59], v[168:171]
    s_cmp_ge_u32 s44, 6
    s_cselect_b32 s68, 0x7f000000, s51
    s_cselect_b32 s69, 0x7f000000, s52
    v_mfma_f32_16x16x32_bf16 v[172:175], v[76:79], v[60:63], v[172:175]
    s_cmp_lt_u32 s44, 8
    s_cbranch_scc1 G1_LOOP
    s_mul_i32 s3, s71, 384
    s_mul_i32 s55, s72, 192
    s_add_u32 s55, s55, 153600
    s_add_u32 s3, s3, s55
    v_lshlrev_b32 v5, 4, v4
    v_add_u32 v6, s3, v5
    s_mul_i32 s3, s71, 384
    s_sub_u32 s3, s55, s3
    s_add_u32 s3, s3, 384
    v_add_u32 v5, s3, v5
    ds_write_b128 v6, v[176:179] offset:0
    ds_write_b128 v6, v[180:183] offset:64
    ds_write_b128 v6, v[184:187] offset:128
    s_mov_b32 s63, 0
G1_PT:
    s_sleep 2
    ds_read_b32 v248, v246 offset:52
    s_add_u32 s63, s63, 1
    s_waitcnt lgkmcnt(0)
    v_readfirstlane_b32 s62, v248
    s_lshr_b32 s97, s63, 22
    s_lshl_b32 s97, s97, 8
    s_add_u32 s62, s62, s97
    s_cmp_lt_u32 s62, 1
    s_cbranch_scc1 G1_PT
    v_mov_b32 v7, 154432
    ds_read_b64 v[8:9], v7
    v_and_b32 v11, 1, v3
    v_cmp_eq_u32 s[56:57], 1, v11
    s_waitcnt vmcnt(0) lgkmcnt(0)
    s_mov_b64 exec, 1
    ds_add_u32 v246, v247 offset:0
    s_mov_b64 exec, -1
    v_readfirstlane_b32 s76, v8
    v_readfirstlane_b32 s77, v9
    s_mov_b32 s63, 0
G1_SP:
    s_nop 0
    v_cmp_ne_u64 vcc, s[76:77], v[222:223]
    v_cmp_ne_u64 s[60:61], s[76:77], v[226:227]
    s_nop 1
    s_or_b64 vcc, vcc, s[60:61]
    v_cmp_ne_u64 s[60:61], s[76:77], v[230:231]
    s_nop 1
    s_or_b64 vcc, vcc, s[60:61]
    v_cmp_ne_u64 s[60:61], s[76:77], v[234:235]
    s_nop 1
    s_or_b64 vcc, vcc, s[60:61]
    s_add_u32 s63, s63, 1
    s_cmp_gt_u32 s63, 0x10000
    s_cbranch_scc1 G1_SPX
    s_cmp_eq_u64 vcc, 0
    s_cbranch_scc1 G1_SPX
    s_sleep 4
    buffer_load_dwordx4 v[220:223], v26, s[12:15], s75 offen offset:0 sc1
    buffer_load_dwordx4 v[224:227], v26, s[12:15], s75 offen offset:128 sc1
    buffer_load_dwordx4 v[228:231], v26, s[12:15], s75 offen offset:256 sc1
    buffer_load_dwordx4 v[232:235], v26, s[12:15], s75 offen offset:384 sc1
    s_waitcnt vmcnt(0)
    s_branch G1_SP
G1_SPX:
    s_cmp_eq_u32 s71, 0
    s_cselect_b32 s60, 0, 0xff800000
    s_cselect_b32 s61, 0xff800000, 0
    v_cndmask_b32 v11, v220, v221, s[56:57]
    v_and_b32 v17, 0xffff0000, v11
    v_lshlrev_b32 v16, 16, v11
    v_rcp_f32 v17, v17
    v_cndmask_b32 v11, v224, v225, s[56:57]
    v_and_b32 v19, 0xffff0000, v11
    v_lshlrev_b32 v18, 16, v11
    v_rcp_f32 v19, v19
    v_cndmask_b32 v11, v228, v229, s[56:57]
    v_and_b32 v21, 0xffff0000, v11
    v_lshlrev_b32 v20, 16, v11
    v_rcp_f32 v21, v21
    v_cndmask_b32 v11, v232, v233, s[56:57]
    v_and_b32 v23, 0xffff0000, v11
    v_lshlrev_b32 v22, 16, v11
    v_rcp_f32 v23, v23
    s_mov_b32 s63, 0
G1_P2:
    ds_read_b32 v248, v246 offset:0
    s_add_u32 s63, s63, 1
    s_waitcnt lgkmcnt(0)
    v_readfirstlane_b32 s62, v248
    s_lshr_b32 s97, s63, 22
    s_lshl_b32 s97, s97, 8
    s_add_u32 s62, s62, s97
    s_cmp_lt_u32 s62, 40
    s_cbranch_scc1 G1_P2
    ds_read_b128 v[64:67], v5 offset:0
    ds_read_b128 v[68:71], v5 offset:64
    ds_read_b128 v[72:75], v5 offset:128
    s_waitcnt lgkmcnt(0)
    v_mul_f32 v24, v17, v17
    v_pk_fma_f32 v[80:81], v[176:177], v[16:17], v[80:81] op_sel_hi:[1,0,1]
    v_pk_fma_f32 v[128:129], v[64:65], v[16:17], v[128:129] op_sel_hi:[1,0,1]
    v_pk_fma_f32 v[82:83], v[178:179], v[16:17], v[82:83] op_sel_hi:[1,0,1]
    v_pk_fma_f32 v[130:131], v[66:67], v[16:17], v[130:131] op_sel_hi:[1,0,1]
    v_max_f32 v80, s60, v80
    v_max_f32 v128, s61, v128
    v_max_f32 v81, s60, v81
    v_max_f32 v129, s61, v129
    v_max_f32 v82, s60, v82
    v_max_f32 v130, s61, v130
    v_max_f32 v83, s60, v83
    v_max_f32 v131, s61, v131
    v_pk_mul_f32 v[80:81], v[80:81], v[128:129]
    v_pk_mul_f32 v[82:83], v[82:83], v[130:131]
    v_pk_mul_f32 v[80:81], v[80:81], v[24:25] op_sel_hi:[1,0]
    v_pk_mul_f32 v[82:83], v[82:83], v[24:25] op_sel_hi:[1,0]
    v_cvt_pk_bf16_f32 v32, v80, v81
    v_cvt_pk_bf16_f32 v33, v82, v83
    v_pk_fma_f32 v[96:97], v[180:181], v[16:17], v[96:97] op_sel_hi:[1,0,1]
    v_pk_fma_f32 v[144:145], v[68:69], v[16:17], v[144:145] op_sel_hi:[1,0,1]
    v_pk_fma_f32 v[98:99], v[182:183], v[16:17], v[98:99] op_sel_hi:[1,0,1]
    v_pk_fma_f32 v[146:147], v[70:71], v[16:17], v[146:147] op_sel_hi:[1,0,1]
    v_max_f32 v96, s60, v96
    v_max_f32 v144, s61, v144
    v_max_f32 v97, s60, v97
    v_max_f32 v145, s61, v145
    v_max_f32 v98, s60, v98
    v_max_f32 v146, s61, v146
    v_max_f32 v99, s60, v99
    v_max_f32 v147, s61, v147
    v_pk_mul_f32 v[96:97], v[96:97], v[144:145]
    v_pk_mul_f32 v[98:99], v[98:99], v[146:147]
    v_pk_mul_f32 v[96:97], v[96:97], v[24:25] op_sel_hi:[1,0]
    v_pk_mul_f32 v[98:99], v[98:99], v[24:25] op_sel_hi:[1,0]
    v_cvt_pk_bf16_f32 v34, v96, v97
    v_cvt_pk_bf16_f32 v35, v98, v99
    v_pk_fma_f32 v[112:113], v[184:185], v[16:17], v[112:113] op_sel_hi:[1,0,1]
    v_pk_fma_f32 v[160:161], v[72:73], v[16:17], v[160:161] op_sel_hi:[1,0,1]
    v_pk_fma_f32 v[114:115], v[186:187], v[16:17], v[114:115] op_sel_hi:[1,0,1]
    v_pk_fma_f32 v[162:163], v[74:75], v[16:17], v[162:163] op_sel_hi:[1,0,1]
    v_max_f32 v112, s60, v112
    v_max_f32 v160, s61, v160
    v_max_f32 v113, s60, v113
    v_max_f32 v161, s61, v161
    v_max_f32 v114, s60, v114
    v_max_f32 v162, s61, v162
    v_max_f32 v115, s60, v115
    v_max_f32 v163, s61, v163
    v_pk_mul_f32 v[112:113], v[112:113], v[160:161]
    v_pk_mul_f32 v[114:115], v[114:115], v[162:163]
    v_pk_mul_f32 v[112:113], v[112:113], v[24:25] op_sel_hi:[1,0]
    v_pk_mul_f32 v[114:115], v[114:115], v[24:25] op_sel_hi:[1,0]
    v_cvt_pk_bf16_f32 v36, v112, v113
    v_cvt_pk_bf16_f32 v37, v114, v115
    v_mul_f32 v24, v19, v19
    v_pk_fma_f32 v[84:85], v[176:177], v[18:19], v[84:85] op_sel_hi:[1,0,1]
    v_pk_fma_f32 v[132:133], v[64:65], v[18:19], v[132:133] op_sel_hi:[1,0,1]
    v_pk_fma_f32 v[86:87], v[178:179], v[18:19], v[86:87] op_sel_hi:[1,0,1]
    v_pk_fma_f32 v[134:135], v[66:67], v[18:19], v[134:135] op_sel_hi:[1,0,1]
    v_max_f32 v84, s60, v84
    v_max_f32 v132, s61, v132
    v_max_f32 v85, s60, v85
    v_max_f32 v133, s61, v133
    v_max_f32 v86, s60, v86
    v_max_f32 v134, s61, v134
    v_max_f32 v87, s60, v87
    v_max_f32 v135, s61, v135
    v_pk_mul_f32 v[84:85], v[84:85], v[132:133]
    v_pk_mul_f32 v[86:87], v[86:87], v[134:135]
    v_pk_mul_f32 v[84:85], v[84:85], v[24:25] op_sel_hi:[1,0]
    v_pk_mul_f32 v[86:87], v[86:87], v[24:25] op_sel_hi:[1,0]
    v_cvt_pk_bf16_f32 v40, v84, v85
    v_cvt_pk_bf16_f32 v41, v86, v87
    v_pk_fma_f32 v[100:101], v[180:181], v[18:19], v[100:101] op_sel_hi:[1,0,1]
    v_pk_fma_f32 v[148:149], v[68:69], v[18:19], v[148:149] op_sel_hi:[1,0,1]
    v_pk_fma_f32 v[102:103], v[182:183], v[18:19], v[102:103] op_sel_hi:[1,0,1]
    v_pk_fma_f32 v[150:151], v[70:71], v[18:19], v[150:151] op_sel_hi:[1,0,1]
    v_max_f32 v100, s60, v100
    v_max_f32 v148, s61, v148
    v_max_f32 v101, s60, v101
    v_max_f32 v149, s61, v149
    v_max_f32 v102, s60, v102
    v_max_f32 v150, s61, v150
    v_max_f32 v103, s60, v103
    v_max_f32 v151, s61, v151
    v_pk_mul_f32 v[100:101], v[100:101], v[148:149]
    v_pk_mul_f32 v[102:103], v[102:103], v[150:151]
    v_pk_mul_f32 v[100:101], v[100:101], v[24:25] op_sel_hi:[1,0]
    v_pk_mul_f32 v[102:103], v[102:103], v[24:25] op_sel_hi:[1,0]
    v_cvt_pk_bf16_f32 v42, v100, v101
    v_cvt_pk_bf16_f32 v43, v102, v103
    v_pk_fma_f32 v[116:117], v[184:185], v[18:19], v[116:117] op_sel_hi:[1,0,1]
    v_pk_fma_f32 v[164:165], v[72:73], v[18:19], v[164:165] op_sel_hi:[1,0,1]
    v_pk_fma_f32 v[118:119], v[186:187], v[18:19], v[118:119] op_sel_hi:[1,0,1]
    v_pk_fma_f32 v[166:167], v[74:75], v[18:19], v[166:167] op_sel_hi:[1,0,1]
    v_max_f32 v116, s60, v116
    v_max_f32 v164, s61, v164
    v_max_f32 v117, s60, v117
    v_max_f32 v165, s61, v165
    v_max_f32 v118, s60, v118
    v_max_f32 v166, s61, v166
    v_max_f32 v119, s60, v119
    v_max_f32 v167, s61, v167
    v_pk_mul_f32 v[116:117], v[116:117], v[164:165]
    v_pk_mul_f32 v[118:119], v[118:119], v[166:167]
    v_pk_mul_f32 v[116:117], v[116:117], v[24:25] op_sel_hi:[1,0]
    v_pk_mul_f32 v[118:119], v[118:119], v[24:25] op_sel_hi:[1,0]
    v_cvt_pk_bf16_f32 v44, v116, v117
    v_cvt_pk_bf16_f32 v45, v118, v119
    v_mul_f32 v24, v21, v21
    v_pk_fma_f32 v[88:89], v[176:177], v[20:21], v[88:89] op_sel_hi:[1,0,1]
    v_pk_fma_f32 v[136:137], v[64:65], v[20:21], v[136:137] op_sel_hi:[1,0,1]
    v_pk_fma_f32 v[90:91], v[178:179], v[20:21], v[90:91] op_sel_hi:[1,0,1]
    v_pk_fma_f32 v[138:139], v[66:67], v[20:21], v[138:139] op_sel_hi:[1,0,1]
    v_max_f32 v88, s60, v88
    v_max_f32 v136, s61, v136
    v_max_f32 v89, s60, v89
    v_max_f32 v137, s61, v137
    v_max_f32 v90, s60, v90
    v_max_f32 v138, s61, v138
    v_max_f32 v91, s60, v91
    v_max_f32 v139, s61, v139
    v_pk_mul_f32 v[88:89], v[88:89], v[136:137]
    v_pk_mul_f32 v[90:91], v[90:91], v[138:139]
    v_pk_mul_f32 v[88:89], v[88:89], v[24:25] op_sel_hi:[1,0]
    v_pk_mul_f32 v[90:91], v[90:91], v[24:25] op_sel_hi:[1,0]
    v_cvt_pk_bf16_f32 v48, v88, v89
    v_cvt_pk_bf16_f32 v49, v90, v91
    v_pk_fma_f32 v[104:105], v[180:181], v[20:21], v[104:105] op_sel_hi:[1,0,1]
    v_pk_fma_f32 v[152:153], v[68:69], v[20:21], v[152:153] op_sel_hi:[1,0,1]
    v_pk_fma_f32 v[106:107], v[182:183], v[20:21], v[106:107] op_sel_hi:[1,0,1]
    v_pk_fma_f32 v[154:155], v[70:71], v[20:21], v[154:155] op_sel_hi:[1,0,1]
    v_max_f32 v104, s60, v104
    v_max_f32 v152, s61, v152
    v_max_f32 v105, s60, v105
    v_max_f32 v153, s61, v153
    v_max_f32 v106, s60, v106
    v_max_f32 v154, s61, v154
    v_max_f32 v107, s60, v107
    v_max_f32 v155, s61, v155
    v_pk_mul_f32 v[104:105], v[104:105], v[152:153]
    v_pk_mul_f32 v[106:107], v[106:107], v[154:155]
    v_pk_mul_f32 v[104:105], v[104:105], v[24:25] op_sel_hi:[1,0]
    v_pk_mul_f32 v[106:107], v[106:107], v[24:25] op_sel_hi:[1,0]
    v_cvt_pk_bf16_f32 v50, v104, v105
    v_cvt_pk_bf16_f32 v51, v106, v107
    v_pk_fma_f32 v[120:121], v[184:185], v[20:21], v[120:121] op_sel_hi:[1,0,1]
    v_pk_fma_f32 v[168:169], v[72:73], v[20:21], v[168:169] op_sel_hi:[1,0,1]
    v_pk_fma_f32 v[122:123], v[186:187], v[20:21], v[122:123] op_sel_hi:[1,0,1]
    v_pk_fma_f32 v[170:171], v[74:75], v[20:21], v[170:171] op_sel_hi:[1,0,1]
    v_max_f32 v120, s60, v120
    v_max_f32 v168, s61, v168
    v_max_f32 v121, s60, v121
    v_max_f32 v169, s61, v169
    v_max_f32 v122, s60, v122
    v_max_f32 v170, s61, v170
    v_max_f32 v123, s60, v123
    v_max_f32 v171, s61, v171
    v_pk_mul_f32 v[120:121], v[120:121], v[168:169]
    v_pk_mul_f32 v[122:123], v[122:123], v[170:171]
    v_pk_mul_f32 v[120:121], v[120:121], v[24:25] op_sel_hi:[1,0]
    v_pk_mul_f32 v[122:123], v[122:123], v[24:25] op_sel_hi:[1,0]
    v_cvt_pk_bf16_f32 v52, v120, v121
    v_cvt_pk_bf16_f32 v53, v122, v123
    v_mul_f32 v24, v23, v23
    v_pk_fma_f32 v[92:93], v[176:177], v[22:23], v[92:93] op_sel_hi:[1,0,1]
    v_pk_fma_f32 v[140:141], v[64:65], v[22:23], v[140:141] op_sel_hi:[1,0,1]
    v_pk_fma_f32 v[94:95], v[178:179], v[22:23], v[94:95] op_sel_hi:[1,0,1]
    v_pk_fma_f32 v[142:143], v[66:67], v[22:23], v[142:143] op_sel_hi:[1,0,1]
    v_max_f32 v92, s60, v92
    v_max_f32 v140, s61, v140
    v_max_f32 v93, s60, v93
    v_max_f32 v141, s61, v141
    v_max_f32 v94, s60, v94
    v_max_f32 v142, s61, v142
    v_max_f32 v95, s60, v95
    v_max_f32 v143, s61, v143
    v_pk_mul_f32 v[92:93], v[92:93], v[140:141]
    v_pk_mul_f32 v[94:95], v[94:95], v[142:143]
    v_pk_mul_f32 v[92:93], v[92:93], v[24:25] op_sel_hi:[1,0]
    v_pk_mul_f32 v[94:95], v[94:95], v[24:25] op_sel_hi:[1,0]
    v_cvt_pk_bf16_f32 v56, v92, v93
    v_cvt_pk_bf16_f32 v57, v94, v95
    v_pk_fma_f32 v[108:109], v[180:181], v[22:23], v[108:109] op_sel_hi:[1,0,1]
    v_pk_fma_f32 v[156:157], v[68:69], v[22:23], v[156:157] op_sel_hi:[1,0,1]
    v_pk_fma_f32 v[110:111], v[182:183], v[22:23], v[110:111] op_sel_hi:[1,0,1]
    v_pk_fma_f32 v[158:159], v[70:71], v[22:23], v[158:159] op_sel_hi:[1,0,1]
    v_max_f32 v108, s60, v108
    v_max_f32 v156, s61, v156
    v_max_f32 v109, s60, v109
    v_max_f32 v157, s61, v157
    v_max_f32 v110, s60, v110
    v_max_f32 v158, s61, v158
    v_max_f32 v111, s60, v111
    v_max_f32 v159, s61, v159
    v_pk_mul_f32 v[108:109], v[108:109], v[156:157]
    v_pk_mul_f32 v[110:111], v[110:111], v[158:159]
    v_pk_mul_f32 v[108:109], v[108:109], v[24:25] op_sel_hi:[1,0]
    v_pk_mul_f32 v[110:111], v[110:111], v[24:25] op_sel_hi:[1,0]
    v_cvt_pk_bf16_f32 v58, v108, v109
    v_cvt_pk_bf16_f32 v59, v110, v111
    v_pk_fma_f32 v[124:125], v[184:185], v[22:23], v[124:125] op_sel_hi:[1,0,1]
    v_pk_fma_f32 v[172:173], v[72:73], v[22:23], v[172:173] op_sel_hi:[1,0,1]
    v_pk_fma_f32 v[126:127], v[186:187], v[22:23], v[126:127] op_sel_hi:[1,0,1]
    v_pk_fma_f32 v[174:175], v[74:75], v[22:23], v[174:175] op_sel_hi:[1,0,1]
    v_max_f32 v124, s60, v124
    v_max_f32 v172, s61, v172
    v_max_f32 v125, s60, v125
    v_max_f32 v173, s61, v173
    v_max_f32 v126, s60, v126
    v_max_f32 v174, s61, v174
    v_max_f32 v127, s60, v127
    v_max_f32 v175, s61, v175
    v_pk_mul_f32 v[124:125], v[124:125], v[172:173]
    v_pk_mul_f32 v[126:127], v[126:127], v[174:175]
    v_pk_mul_f32 v[124:125], v[124:125], v[24:25] op_sel_hi:[1,0]
    v_pk_mul_f32 v[126:127], v[126:127], v[24:25] op_sel_hi:[1,0]
    v_cvt_pk_bf16_f32 v60, v124, v125
    v_cvt_pk_bf16_f32 v61, v126, v127
    s_lshl_b32 s3, s42, 10
    s_add_u32 s3, s3, 155648
    v_add_u32 v5, s3, v27
    v_xor_b32 v6, 0x400, v5
    s_cmp_lg_u32 s72, 0
    s_cbranch_scc1 G1_ST1
    ds_write2_b64 v5, v[52:53], v[60:61] offset0:0 offset1:1
    s_waitcnt lgkmcnt(0)
    s_mov_b64 exec, 1
    ds_add_u32 v246, v247 offset:56
    s_mov_b64 exec, -1
    buffer_store_dwordx4 v[32:35], v27, s[12:15], s73 offen offset:0 sc1
    buffer_store_dwordx4 v[40:43], v27, s[12:15], s73 offen offset:1024 sc1
    buffer_store_dwordx4 v[48:51], v27, s[12:15], s73 offen offset:2048 sc1
    buffer_store_dwordx4 v[56:59], v27, s[12:15], s73 offen offset:3072 sc1
    s_mov_b32 s63, 0
G1_PX0:
    ds_read_b32 v248, v246 offset:56
    s_add_u32 s63, s63, 1
    s_waitcnt lgkmcnt(0)
    v_readfirstlane_b32 s62, v248
    s_lshr_b32 s97, s63, 22
    s_lshl_b32 s97, s97, 8
    s_add_u32 s62, s62, s97
    s_cmp_lt_u32 s62, 4
    s_cbranch_scc1 G1_PX0
    ds_read_b64 v[38:39], v6
    ds_read_b64 v[46:47], v6 offset:8
    s_waitcnt lgkmcnt(0)
    buffer_store_dwordx4 v[36:39], v27, s[12:15], s74 offen offset:0 sc1
    buffer_store_dwordx4 v[44:47], v27, s[12:15], s74 offen offset:1024 sc1
    s_branch G2_PUB
G1_ST1:
    ds_write2_b64 v5, v[32:33], v[40:41] offset0:0 offset1:1
    s_waitcnt lgkmcnt(0)
    s_mov_b64 exec, 1
    ds_add_u32 v246, v247 offset:56
    s_mov_b64 exec, -1
    buffer_store_dwordx4 v[34:37], v27, s[12:15], s73 offen offset:0 sc1
    buffer_store_dwordx4 v[42:45], v27, s[12:15], s73 offen offset:1024 sc1
    buffer_store_dwordx4 v[50:53], v27, s[12:15], s73 offen offset:2048 sc1
    buffer_store_dwordx4 v[58:61], v27, s[12:15], s73 offen offset:3072 sc1
    s_mov_b32 s63, 0
G1_PX1:
    ds_read_b32 v248, v246 offset:56
    s_add_u32 s63, s63, 1
    s_waitcnt lgkmcnt(0)
    v_readfirstlane_b32 s62, v248
    s_lshr_b32 s97, s63, 22
    s_lshl_b32 s97, s97, 8
    s_add_u32 s62, s62, s97
    s_cmp_lt_u32 s62, 4
    s_cbranch_scc1 G1_PX1
    ds_read_b64 v[46:47], v6
    ds_read_b64 v[54:55], v6 offset:8
    s_waitcnt lgkmcnt(0)
    buffer_store_dwordx4 v[46:49], v27, s[12:15], s74 offen offset:0 sc1
    buffer_store_dwordx4 v[54:57], v27, s[12:15], s74 offen offset:1024 sc1
G2_PUB:
G2_START:
    v_lshlrev_b32 v1, 4, v2
    v_cmp_ne_u64 vcc, s[76:77], v[238:239]
    s_nop 1
    s_cmp_eq_u64 vcc, 0
    s_cbranch_scc1 G2_FP_X
    s_mov_b32 s63, 0
G2_FP:
    buffer_load_dwordx2 v[238:239], v236, s[12:15], s59 offen sc1
    s_add_u32 s63, s63, 1
    s_waitcnt vmcnt(0)
    v_cmp_ne_u64 vcc, s[76:77], v[238:239]
    s_cmp_gt_u32 s63, 0x10000
    s_cbranch_scc1 G2_FP_X
    s_cmp_eq_u64 vcc, 0
    s_cbranch_scc1 G2_FP_X
    s_sleep 2
    s_branch G2_FP
G2_FP_X:
    s_mul_i32 s3, s42, 11
    s_mul_i32 s48, s78, 43
    s_add_u32 s48, s48, s3
    s_lshl_b32 s48, s48, 12
    s_mul_i32 s49, s79, 43
    s_add_u32 s49, s49, s3
    s_lshl_b32 s49, s49, 12
    s_add_u32 s49, s49, 6291456
    s_cmp_eq_u32 s42, 3
    s_cselect_b32 s57, 10, 11
    s_lshl_b32 s56, s79, 2
    s_cmp_ge_u32 s56, s57
    s_cselect_b32 s3, s57, 0
    s_sub_u32 s56, s56, s3
    s_cmp_ge_u32 s56, s57
    s_cselect_b32 s3, s57, 0
    s_sub_u32 s56, s56, s3
    s_cmp_ge_u32 s56, s57
    s_cselect_b32 s3, s57, 0
    s_sub_u32 s56, s56, s3
    s_lshl_b32 s56, s56, 12
    s_lshl_b32 s57, s57, 12
    s_mov_b32 s58, s56
    v_mov_b32 v245, v237
    v_lshrrev_b32 v5, 3, v0
    v_and_b32 v6, 7, v0
    v_lshlrev_b32 v7, 10, v5
    v_lshl_add_u32 v7, v6, 4, v7
    v_lshlrev_b32 v8, 4, v6
    s_lshl_b32 s44, s78, 16
    s_lshl_b32 s45, s79, 7
    s_add_u32 s44, s44, s45
    s_lshr_b32 s46, s78, 4
    s_lshl_b32 s46, s46, 12
    s_lshl_b32 s3, s78, 8
    s_add_u32 s46, s46, s3
    s_add_u32 s46, s46, 122880
    v_lshlrev_b32 v9, 2, v5
    v_add_u32 v9, s46, v9
    s_mov_b64 s[8:9], s[28:29]
    s_mov_b32 s10, 1024
    s_mov_b32 s11, 0x00020000
    buffer_load_dwordx4 v[232:235], v7, s[4:7], s44 offen
    buffer_load_dwordx4 v[236:239], v8, s[8:11], s45 offen
    v_mov_b32 v244, v9
    s_add_u32 s51, s49, s58
    buffer_load_dwordx4 v[72:75], v1, s[12:15], s51 offen offset:0 sc1
    buffer_load_dwordx4 v[76:79], v1, s[12:15], s51 offen offset:1024 sc1
    buffer_load_dwordx4 v[80:83], v1, s[12:15], s51 offen offset:2048 sc1
    buffer_load_dwordx4 v[84:87], v1, s[12:15], s51 offen offset:3072 sc1
    s_add_u32 s58, s58, 4096
    s_cmp_eq_u32 s58, s57
    s_cselect_b32 s58, 0, s58
    s_add_u32 s51, s49, s58
    buffer_load_dwordx4 v[104:107], v1, s[12:15], s51 offen offset:0 sc1
    buffer_load_dwordx4 v[108:111], v1, s[12:15], s51 offen offset:1024 sc1
    buffer_load_dwordx4 v[112:115], v1, s[12:15], s51 offen offset:2048 sc1
    buffer_load_dwordx4 v[116:119], v1, s[12:15], s51 offen offset:3072 sc1
    s_add_u32 s58, s58, 4096
    s_cmp_eq_u32 s58, s57
    s_cselect_b32 s58, 0, s58
    s_add_u32 s51, s49, s58
    buffer_load_dwordx4 v[136:139], v1, s[12:15], s51 offen offset:0 sc1
    buffer_load_dwordx4 v[140:143], v1, s[12:15], s51 offen offset:1024 sc1
    buffer_load_dwordx4 v[144:147], v1, s[12:15], s51 offen offset:2048 sc1
    buffer_load_dwordx4 v[148:151], v1, s[12:15], s51 offen offset:3072 sc1
    s_add_u32 s58, s58, 4096
    s_cmp_eq_u32 s58, s57
    s_cselect_b32 s58, 0, s58
    s_add_u32 s51, s49, s58
    buffer_load_dwordx4 v[168:171], v1, s[12:15], s51 offen offset:0 sc1
    buffer_load_dwordx4 v[172:175], v1, s[12:15], s51 offen offset:1024 sc1
    buffer_load_dwordx4 v[176:179], v1, s[12:15], s51 offen offset:2048 sc1
    buffer_load_dwordx4 v[180:183], v1, s[12:15], s51 offen offset:3072 sc1
    s_add_u32 s58, s58, 4096
    s_cmp_eq_u32 s58, s57
    s_cselect_b32 s58, 0, s58
    s_add_u32 s51, s49, s58
    buffer_load_dwordx4 v[200:203], v1, s[12:15], s51 offen offset:0 sc1
    buffer_load_dwordx4 v[204:207], v1, s[12:15], s51 offen offset:1024 sc1
    buffer_load_dwordx4 v[208:211], v1, s[12:15], s51 offen offset:2048 sc1
    buffer_load_dwordx4 v[212:215], v1, s[12:15], s51 offen offset:3072 sc1
    s_add_u32 s58, s58, 4096
    s_cmp_eq_u32 s58, s57
    s_cselect_b32 s58, 0, s58
    s_lshl_b32 s3, s40, 4
    s_add_u32 s3, s3, s41
    s_lshl_b32 s3, s3, 7
    s_add_u32 s59, s3, 16941056
    s_mov_b32 s58, 16941056
    s_waitcnt vmcnt(22)
    s_mov_b64 exec, 1
    ds_add_rtn_u32 v248, v246, v247 offset:40
    s_waitcnt lgkmcnt(0)
    s_mov_b64 exec, -1
    v_readfirstlane_b32 s62, v248
    s_nop 1
    s_cmp_lg_u32 s62, 3
    s_cbranch_scc1 G2_NP
    v_mov_b32 v8, s76
    v_mov_b32 v9, s77
    v_mov_b32 v10, s76
    v_mov_b32 v11, s77
    s_mov_b64 exec, 0xff
    buffer_store_dwordx4 v[8:11], v1, s[12:15], s59 offen sc1
    s_mov_b64 exec, -1
G2_NP:
    s_setprio 0
    s_mov_b32 s63, 0
G2_PS:
    s_sleep 2
    ds_read_b32 v248, v246 offset:8
    s_add_u32 s63, s63, 1
    s_waitcnt lgkmcnt(0)
    v_readfirstlane_b32 s62, v248
    s_lshr_b32 s97, s63, 22
    s_lshl_b32 s97, s97, 8
    s_add_u32 s62, s62, s97
    s_cmp_lt_u32 s62, 2
    s_cbranch_scc1 G2_PS
    ds_read_b32 v240, v244
    s_waitcnt vmcnt(20) lgkmcnt(0)
    v_and_b32 v242, 0xffff0000, v240
    v_lshlrev_b32 v240, 16, v240
    v_rcp_f32 v242, v242
    v_lshlrev_b32 v12, 16, v232
    v_and_b32 v13, 0xffff0000, v232
    v_lshlrev_b32 v14, 16, v233
    v_and_b32 v15, 0xffff0000, v233
    v_lshlrev_b32 v16, 16, v234
    v_and_b32 v17, 0xffff0000, v234
    v_lshlrev_b32 v18, 16, v235
    v_and_b32 v19, 0xffff0000, v235
    v_lshlrev_b32 v28, 16, v236
    v_and_b32 v29, 0xffff0000, v236
    v_lshlrev_b32 v30, 16, v237
    v_and_b32 v31, 0xffff0000, v237
    v_lshlrev_b32 v32, 16, v238
    v_and_b32 v33, 0xffff0000, v238
    v_lshlrev_b32 v34, 16, v239
    v_and_b32 v35, 0xffff0000, v239
    v_pk_add_f32 v[20:21], v[12:13], v[240:241] op_sel_hi:[1,0]
    v_pk_add_f32 v[22:23], v[14:15], v[240:241] op_sel_hi:[1,0]
    v_pk_add_f32 v[24:25], v[16:17], v[240:241] op_sel_hi:[1,0]
    v_pk_add_f32 v[26:27], v[18:19], v[240:241] op_sel_hi:[1,0]
    v_cvt_pk_bf16_f32 v36, v20, v21
    v_cvt_pk_bf16_f32 v37, v22, v23
    v_cvt_pk_bf16_f32 v38, v24, v25
    v_cvt_pk_bf16_f32 v39, v26, v27
    v_lshlrev_b32 v20, 16, v36
    v_and_b32 v21, 0xffff0000, v36
    v_lshlrev_b32 v22, 16, v37
    v_and_b32 v23, 0xffff0000, v37
    v_lshlrev_b32 v24, 16, v38
    v_and_b32 v25, 0xffff0000, v38
    v_lshlrev_b32 v26, 16, v39
    v_and_b32 v27, 0xffff0000, v39
    v_pk_mul_f32 v[20:21], v[20:21], v[242:243] op_sel_hi:[1,0]
    v_pk_mul_f32 v[22:23], v[22:23], v[242:243] op_sel_hi:[1,0]
    v_pk_mul_f32 v[24:25], v[24:25], v[242:243] op_sel_hi:[1,0]
    v_pk_mul_f32 v[26:27], v[26:27], v[242:243] op_sel_hi:[1,0]
    v_cvt_pk_bf16_f32 v36, v20, v21
    v_cvt_pk_bf16_f32 v37, v22, v23
    v_cvt_pk_bf16_f32 v38, v24, v25
    v_cvt_pk_bf16_f32 v39, v26, v27
    v_lshlrev_b32 v20, 16, v36
    v_and_b32 v21, 0xffff0000, v36
    v_lshlrev_b32 v22, 16, v37
    v_and_b32 v23, 0xffff0000, v37
    v_lshlrev_b32 v24, 16, v38
    v_and_b32 v25, 0xffff0000, v38
    v_lshlrev_b32 v26, 16, v39
    v_and_b32 v27, 0xffff0000, v39
    v_pk_mul_f32 v[20:21], v[20:21], v[28:29]
    v_pk_mul_f32 v[22:23], v[22:23], v[30:31]
    v_pk_mul_f32 v[24:25], v[24:25], v[32:33]
    v_pk_mul_f32 v[26:27], v[26:27], v[34:35]
    v_cvt_pk_bf16_f32 v236, v20, v21
    v_cvt_pk_bf16_f32 v237, v22, v23
    v_cvt_pk_bf16_f32 v238, v24, v25
    v_cvt_pk_bf16_f32 v239, v26, v27
    v_mov_b32 v6, 0
    v_mov_b32 v7, 0
    v_pk_mov_b32 v[8:9], v[6:7], v[6:7]
    v_pk_mov_b32 v[10:11], v[6:7], v[6:7]
    v_pk_mov_b32 v[12:13], v[6:7], v[6:7]
    v_pk_mov_b32 v[14:15], v[6:7], v[6:7]
    v_pk_mov_b32 v[16:17], v[6:7], v[6:7]
    v_pk_mov_b32 v[18:19], v[6:7], v[6:7]
    v_pk_mov_b32 v[20:21], v[6:7], v[6:7]
    v_pk_mov_b32 v[22:23], v[6:7], v[6:7]
    v_pk_mov_b32 v[24:25], v[6:7], v[6:7]
    v_pk_mov_b32 v[26:27], v[6:7], v[6:7]
    v_pk_mov_b32 v[28:29], v[6:7], v[6:7]
    v_pk_mov_b32 v[30:31], v[6:7], v[6:7]
    v_pk_mov_b32 v[32:33], v[6:7], v[6:7]
    v_pk_mov_b32 v[34:35], v[6:7], v[6:7]
    v_pk_mov_b32 v[36:37], v[6:7], v[6:7]
    v_pk_mov_b32 v[38:39], v[6:7], v[6:7]
    v_pk_mov_b32 v[40:41], v[6:7], v[6:7]
    v_pk_mov_b32 v[42:43], v[6:7], v[6:7]
    v_pk_mov_b32 v[44:45], v[6:7], v[6:7]
    v_pk_mov_b32 v[46:47], v[6:7], v[6:7]
    v_pk_mov_b32 v[48:49], v[6:7], v[6:7]
    v_pk_mov_b32 v[50:51], v[6:7], v[6:7]
    v_pk_mov_b32 v[52:53], v[6:7], v[6:7]
    v_pk_mov_b32 v[54:55], v[6:7], v[6:7]
    v_pk_mov_b32 v[56:57], v[6:7], v[6:7]
    v_pk_mov_b32 v[58:59], v[6:7], v[6:7]
    v_pk_mov_b32 v[60:61], v[6:7], v[6:7]
    v_pk_mov_b32 v[62:63], v[6:7], v[6:7]
    v_pk_mov_b32 v[64:65], v[6:7], v[6:7]
    v_pk_mov_b32 v[66:67], v[6:7], v[6:7]
    v_pk_mov_b32 v[68:69], v[6:7], v[6:7]
    v_pk_mov_b32 v[70:71], v[6:7], v[6:7]
    s_mov_b32 s63, 0
G2_FH:
    buffer_load_dwordx2 v[6:7], v245, s[12:15], s58 offen sc1
    s_add_u32 s63, s63, 1
    s_waitcnt vmcnt(0)
    v_cmp_ne_u64 vcc, s[76:77], v[6:7]
    s_cmp_gt_u32 s63, 0x10000
    s_cbranch_scc1 G2_FH_X
    s_cmp_eq_u64 vcc, 0
    s_cbranch_scc1 G2_FH_X
    s_sleep 2
    s_branch G2_FH
G2_FH_X:
    s_add_u32 s50, s48, s56
    buffer_load_dwordx4 v[88:91], v1, s[12:15], s50 offen offset:0 sc1
    buffer_load_dwordx4 v[92:95], v1, s[12:15], s50 offen offset:1024 sc1
    buffer_load_dwordx4 v[96:99], v1, s[12:15], s50 offen offset:2048 sc1
    buffer_load_dwordx4 v[100:103], v1, s[12:15], s50 offen offset:3072 sc1
    s_add_u32 s56, s56, 4096
    s_cmp_eq_u32 s56, s57
    s_cselect_b32 s56, 0, s56
    s_add_u32 s50, s48, s56
    buffer_load_dwordx4 v[120:123], v1, s[12:15], s50 offen offset:0 sc1
    buffer_load_dwordx4 v[124:127], v1, s[12:15], s50 offen offset:1024 sc1
    buffer_load_dwordx4 v[128:131], v1, s[12:15], s50 offen offset:2048 sc1
    buffer_load_dwordx4 v[132:135], v1, s[12:15], s50 offen offset:3072 sc1
    s_add_u32 s56, s56, 4096
    s_cmp_eq_u32 s56, s57
    s_cselect_b32 s56, 0, s56
    s_add_u32 s50, s48, s56
    buffer_load_dwordx4 v[152:155], v1, s[12:15], s50 offen offset:0 sc1
    buffer_load_dwordx4 v[156:159], v1, s[12:15], s50 offen offset:1024 sc1
    buffer_load_dwordx4 v[160:163], v1, s[12:15], s50 offen offset:2048 sc1
    buffer_load_dwordx4 v[164:167], v1, s[12:15], s50 offen offset:3072 sc1
    s_add_u32 s56, s56, 4096
    s_cmp_eq_u32 s56, s57
    s_cselect_b32 s56, 0, s56
    s_waitcnt vmcnt(8)
    s_add_u32 s50, s48, s56
    buffer_load_dwordx4 v[184:187], v1, s[12:15], s50 offen offset:0 sc1
    buffer_load_dwordx4 v[188:191], v1, s[12:15], s50 offen offset:1024 sc1
    buffer_load_dwordx4 v[192:195], v1, s[12:15], s50 offen offset:2048 sc1
    buffer_load_dwordx4 v[196:199], v1, s[12:15], s50 offen offset:3072 sc1
    s_add_u32 s56, s56, 4096
    s_cmp_eq_u32 s56, s57
    s_cselect_b32 s56, 0, s56
    v_mfma_f32_16x16x32_bf16 v[8:11], v[72:75], v[88:91], v[8:11]
    v_mfma_f32_16x16x32_bf16 v[12:15], v[72:75], v[92:95], v[12:15]
    v_mfma_f32_16x16x32_bf16 v[16:19], v[72:75], v[96:99], v[16:19]
    v_mfma_f32_16x16x32_bf16 v[20:23], v[72:75], v[100:103], v[20:23]
    v_mfma_f32_16x16x32_bf16 v[24:27], v[76:79], v[88:91], v[24:27]
    v_mfma_f32_16x16x32_bf16 v[28:31], v[76:79], v[92:95], v[28:31]
    v_mfma_f32_16x16x32_bf16 v[32:35], v[76:79], v[96:99], v[32:35]
    v_mfma_f32_16x16x32_bf16 v[36:39], v[76:79], v[100:103], v[36:39]
    v_mfma_f32_16x16x32_bf16 v[40:43], v[80:83], v[88:91], v[40:43]
    v_mfma_f32_16x16x32_bf16 v[44:47], v[80:83], v[92:95], v[44:47]
    v_mfma_f32_16x16x32_bf16 v[48:51], v[80:83], v[96:99], v[48:51]
    v_mfma_f32_16x16x32_bf16 v[52:55], v[80:83], v[100:103], v[52:55]
    v_mfma_f32_16x16x32_bf16 v[56:59], v[84:87], v[88:91], v[56:59]
    v_mfma_f32_16x16x32_bf16 v[60:63], v[84:87], v[92:95], v[60:63]
    v_mfma_f32_16x16x32_bf16 v[64:67], v[84:87], v[96:99], v[64:67]
    v_mfma_f32_16x16x32_bf16 v[68:71], v[84:87], v[100:103], v[68:71]
    s_waitcnt vmcnt(8)
    s_add_u32 s50, s48, s56
    buffer_load_dwordx4 v[216:219], v1, s[12:15], s50 offen offset:0 sc1
    buffer_load_dwordx4 v[220:223], v1, s[12:15], s50 offen offset:1024 sc1
    buffer_load_dwordx4 v[224:227], v1, s[12:15], s50 offen offset:2048 sc1
    buffer_load_dwordx4 v[228:231], v1, s[12:15], s50 offen offset:3072 sc1
    s_add_u32 s56, s56, 4096
    s_cmp_eq_u32 s56, s57
    s_cselect_b32 s56, 0, s56
    v_mfma_f32_16x16x32_bf16 v[8:11], v[104:107], v[120:123], v[8:11]
    v_mfma_f32_16x16x32_bf16 v[12:15], v[104:107], v[124:127], v[12:15]
    v_mfma_f32_16x16x32_bf16 v[16:19], v[104:107], v[128:131], v[16:19]
    v_mfma_f32_16x16x32_bf16 v[20:23], v[104:107], v[132:135], v[20:23]
    v_mfma_f32_16x16x32_bf16 v[24:27], v[108:111], v[120:123], v[24:27]
    v_mfma_f32_16x16x32_bf16 v[28:31], v[108:111], v[124:127], v[28:31]
    v_mfma_f32_16x16x32_bf16 v[32:35], v[108:111], v[128:131], v[32:35]
    v_mfma_f32_16x16x32_bf16 v[36:39], v[108:111], v[132:135], v[36:39]
    v_mfma_f32_16x16x32_bf16 v[40:43], v[112:115], v[120:123], v[40:43]
    v_mfma_f32_16x16x32_bf16 v[44:47], v[112:115], v[124:127], v[44:47]
    v_mfma_f32_16x16x32_bf16 v[48:51], v[112:115], v[128:131], v[48:51]
    v_mfma_f32_16x16x32_bf16 v[52:55], v[112:115], v[132:135], v[52:55]
    v_mfma_f32_16x16x32_bf16 v[56:59], v[116:119], v[120:123], v[56:59]
    v_mfma_f32_16x16x32_bf16 v[60:63], v[116:119], v[124:127], v[60:63]
    v_mfma_f32_16x16x32_bf16 v[64:67], v[116:119], v[128:131], v[64:67]
    v_mfma_f32_16x16x32_bf16 v[68:71], v[116:119], v[132:135], v[68:71]
    s_waitcnt vmcnt(8)
    s_add_u32 s51, s49, s56
    s_add_u32 s50, s48, s56
    buffer_load_dwordx4 v[72:75], v1, s[12:15], s51 offen offset:0 sc1
    buffer_load_dwordx4 v[88:91], v1, s[12:15], s50 offen offset:0 sc1
    buffer_load_dwordx4 v[76:79], v1, s[12:15], s51 offen offset:1024 sc1
    buffer_load_dwordx4 v[92:95], v1, s[12:15], s50 offen offset:1024 sc1
    buffer_load_dwordx4 v[80:83], v1, s[12:15], s51 offen offset:2048 sc1
    buffer_load_dwordx4 v[96:99], v1, s[12:15], s50 offen offset:2048 sc1
    buffer_load_dwordx4 v[84:87], v1, s[12:15], s51 offen offset:3072 sc1
    buffer_load_dwordx4 v[100:103], v1, s[12:15], s50 offen offset:3072 sc1
    s_add_u32 s56, s56, 4096
    s_cmp_eq_u32 s56, s57
    s_cselect_b32 s56, 0, s56
    v_mfma_f32_16x16x32_bf16 v[8:11], v[136:139], v[152:155], v[8:11]
    v_mfma_f32_16x16x32_bf16 v[12:15], v[136:139], v[156:159], v[12:15]
    v_mfma_f32_16x16x32_bf16 v[16:19], v[136:139], v[160:163], v[16:19]
    v_mfma_f32_16x16x32_bf16 v[20:23], v[136:139], v[164:167], v[20:23]
    v_mfma_f32_16x16x32_bf16 v[24:27], v[140:143], v[152:155], v[24:27]
    v_mfma_f32_16x16x32_bf16 v[28:31], v[140:143], v[156:159], v[28:31]
    v_mfma_f32_16x16x32_bf16 v[32:35], v[140:143], v[160:163], v[32:35]
    v_mfma_f32_16x16x32_bf16 v[36:39], v[140:143], v[164:167], v[36:39]
    v_mfma_f32_16x16x32_bf16 v[40:43], v[144:147], v[152:155], v[40:43]
    v_mfma_f32_16x16x32_bf16 v[44:47], v[144:147], v[156:159], v[44:47]
    v_mfma_f32_16x16x32_bf16 v[48:51], v[144:147], v[160:163], v[48:51]
    v_mfma_f32_16x16x32_bf16 v[52:55], v[144:147], v[164:167], v[52:55]
    v_mfma_f32_16x16x32_bf16 v[56:59], v[148:151], v[152:155], v[56:59]
    v_mfma_f32_16x16x32_bf16 v[60:63], v[148:151], v[156:159], v[60:63]
    v_mfma_f32_16x16x32_bf16 v[64:67], v[148:151], v[160:163], v[64:67]
    v_mfma_f32_16x16x32_bf16 v[68:71], v[148:151], v[164:167], v[68:71]
    s_waitcnt vmcnt(12)
    s_add_u32 s51, s49, s56
    s_add_u32 s50, s48, s56
    buffer_load_dwordx4 v[104:107], v1, s[12:15], s51 offen offset:0 sc1
    buffer_load_dwordx4 v[120:123], v1, s[12:15], s50 offen offset:0 sc1
    buffer_load_dwordx4 v[108:111], v1, s[12:15], s51 offen offset:1024 sc1
    buffer_load_dwordx4 v[124:127], v1, s[12:15], s50 offen offset:1024 sc1
    buffer_load_dwordx4 v[112:115], v1, s[12:15], s51 offen offset:2048 sc1
    buffer_load_dwordx4 v[128:131], v1, s[12:15], s50 offen offset:2048 sc1
    buffer_load_dwordx4 v[116:119], v1, s[12:15], s51 offen offset:3072 sc1
    buffer_load_dwordx4 v[132:135], v1, s[12:15], s50 offen offset:3072 sc1
    s_add_u32 s56, s56, 4096
    s_cmp_eq_u32 s56, s57
    s_cselect_b32 s56, 0, s56
    v_mfma_f32_16x16x32_bf16 v[8:11], v[168:171], v[184:187], v[8:11]
    v_mfma_f32_16x16x32_bf16 v[12:15], v[168:171], v[188:191], v[12:15]
    v_mfma_f32_16x16x32_bf16 v[16:19], v[168:171], v[192:195], v[16:19]
    v_mfma_f32_16x16x32_bf16 v[20:23], v[168:171], v[196:199], v[20:23]
    v_mfma_f32_16x16x32_bf16 v[24:27], v[172:175], v[184:187], v[24:27]
    v_mfma_f32_16x16x32_bf16 v[28:31], v[172:175], v[188:191], v[28:31]
    v_mfma_f32_16x16x32_bf16 v[32:35], v[172:175], v[192:195], v[32:35]
    v_mfma_f32_16x16x32_bf16 v[36:39], v[172:175], v[196:199], v[36:39]
    v_mfma_f32_16x16x32_bf16 v[40:43], v[176:179], v[184:187], v[40:43]
    v_mfma_f32_16x16x32_bf16 v[44:47], v[176:179], v[188:191], v[44:47]
    v_mfma_f32_16x16x32_bf16 v[48:51], v[176:179], v[192:195], v[48:51]
    v_mfma_f32_16x16x32_bf16 v[52:55], v[176:179], v[196:199], v[52:55]
    v_mfma_f32_16x16x32_bf16 v[56:59], v[180:183], v[184:187], v[56:59]
    v_mfma_f32_16x16x32_bf16 v[60:63], v[180:183], v[188:191], v[60:63]
    v_mfma_f32_16x16x32_bf16 v[64:67], v[180:183], v[192:195], v[64:67]
    v_mfma_f32_16x16x32_bf16 v[68:71], v[180:183], v[196:199], v[68:71]
    s_waitcnt vmcnt(16)
    s_add_u32 s51, s49, s56
    s_add_u32 s50, s48, s56
    buffer_load_dwordx4 v[136:139], v1, s[12:15], s51 offen offset:0 sc1
    buffer_load_dwordx4 v[152:155], v1, s[12:15], s50 offen offset:0 sc1
    buffer_load_dwordx4 v[140:143], v1, s[12:15], s51 offen offset:1024 sc1
    buffer_load_dwordx4 v[156:159], v1, s[12:15], s50 offen offset:1024 sc1
    buffer_load_dwordx4 v[144:147], v1, s[12:15], s51 offen offset:2048 sc1
    buffer_load_dwordx4 v[160:163], v1, s[12:15], s50 offen offset:2048 sc1
    buffer_load_dwordx4 v[148:151], v1, s[12:15], s51 offen offset:3072 sc1
    buffer_load_dwordx4 v[164:167], v1, s[12:15], s50 offen offset:3072 sc1
    s_add_u32 s56, s56, 4096
    s_cmp_eq_u32 s56, s57
    s_cselect_b32 s56, 0, s56
    v_mfma_f32_16x16x32_bf16 v[8:11], v[200:203], v[216:219], v[8:11]
    v_mfma_f32_16x16x32_bf16 v[12:15], v[200:203], v[220:223], v[12:15]
    v_mfma_f32_16x16x32_bf16 v[16:19], v[200:203], v[224:227], v[16:19]
    v_mfma_f32_16x16x32_bf16 v[20:23], v[200:203], v[228:231], v[20:23]
    v_mfma_f32_16x16x32_bf16 v[24:27], v[204:207], v[216:219], v[24:27]
    v_mfma_f32_16x16x32_bf16 v[28:31], v[204:207], v[220:223], v[28:31]
    v_mfma_f32_16x16x32_bf16 v[32:35], v[204:207], v[224:227], v[32:35]
    v_mfma_f32_16x16x32_bf16 v[36:39], v[204:207], v[228:231], v[36:39]
    v_mfma_f32_16x16x32_bf16 v[40:43], v[208:211], v[216:219], v[40:43]
    v_mfma_f32_16x16x32_bf16 v[44:47], v[208:211], v[220:223], v[44:47]
    v_mfma_f32_16x16x32_bf16 v[48:51], v[208:211], v[224:227], v[48:51]
    v_mfma_f32_16x16x32_bf16 v[52:55], v[208:211], v[228:231], v[52:55]
    v_mfma_f32_16x16x32_bf16 v[56:59], v[212:215], v[216:219], v[56:59]
    v_mfma_f32_16x16x32_bf16 v[60:63], v[212:215], v[220:223], v[60:63]
    v_mfma_f32_16x16x32_bf16 v[64:67], v[212:215], v[224:227], v[64:67]
    v_mfma_f32_16x16x32_bf16 v[68:71], v[212:215], v[228:231], v[68:71]
    s_waitcnt vmcnt(16)
    s_add_u32 s51, s49, s56
    s_add_u32 s50, s48, s56
    buffer_load_dwordx4 v[168:171], v1, s[12:15], s51 offen offset:0 sc1
    buffer_load_dwordx4 v[184:187], v1, s[12:15], s50 offen offset:0 sc1
    buffer_load_dwordx4 v[172:175], v1, s[12:15], s51 offen offset:1024 sc1
    buffer_load_dwordx4 v[188:191], v1, s[12:15], s50 offen offset:1024 sc1
    buffer_load_dwordx4 v[176:179], v1, s[12:15], s51 offen offset:2048 sc1
    buffer_load_dwordx4 v[192:195], v1, s[12:15], s50 offen offset:2048 sc1
    buffer_load_dwordx4 v[180:183], v1, s[12:15], s51 offen offset:3072 sc1
    buffer_load_dwordx4 v[196:199], v1, s[12:15], s50 offen offset:3072 sc1
    s_add_u32 s56, s56, 4096
    s_cmp_eq_u32 s56, s57
    s_cselect_b32 s56, 0, s56
    v_mfma_f32_16x16x32_bf16 v[8:11], v[72:75], v[88:91], v[8:11]
    v_mfma_f32_16x16x32_bf16 v[12:15], v[72:75], v[92:95], v[12:15]
    v_mfma_f32_16x16x32_bf16 v[16:19], v[72:75], v[96:99], v[16:19]
    v_mfma_f32_16x16x32_bf16 v[20:23], v[72:75], v[100:103], v[20:23]
    v_mfma_f32_16x16x32_bf16 v[24:27], v[76:79], v[88:91], v[24:27]
    v_mfma_f32_16x16x32_bf16 v[28:31], v[76:79], v[92:95], v[28:31]
    v_mfma_f32_16x16x32_bf16 v[32:35], v[76:79], v[96:99], v[32:35]
    v_mfma_f32_16x16x32_bf16 v[36:39], v[76:79], v[100:103], v[36:39]
    v_mfma_f32_16x16x32_bf16 v[40:43], v[80:83], v[88:91], v[40:43]
    v_mfma_f32_16x16x32_bf16 v[44:47], v[80:83], v[92:95], v[44:47]
    v_mfma_f32_16x16x32_bf16 v[48:51], v[80:83], v[96:99], v[48:51]
    v_mfma_f32_16x16x32_bf16 v[52:55], v[80:83], v[100:103], v[52:55]
    v_mfma_f32_16x16x32_bf16 v[56:59], v[84:87], v[88:91], v[56:59]
    v_mfma_f32_16x16x32_bf16 v[60:63], v[84:87], v[92:95], v[60:63]
    v_mfma_f32_16x16x32_bf16 v[64:67], v[84:87], v[96:99], v[64:67]
    v_mfma_f32_16x16x32_bf16 v[68:71], v[84:87], v[100:103], v[68:71]
    s_waitcnt vmcnt(16)
    s_add_u32 s51, s49, s56
    s_add_u32 s50, s48, s56
    buffer_load_dwordx4 v[200:203], v1, s[12:15], s51 offen offset:0 sc1
    buffer_load_dwordx4 v[216:219], v1, s[12:15], s50 offen offset:0 sc1
    buffer_load_dwordx4 v[204:207], v1, s[12:15], s51 offen offset:1024 sc1
    buffer_load_dwordx4 v[220:223], v1, s[12:15], s50 offen offset:1024 sc1
    buffer_load_dwordx4 v[208:211], v1, s[12:15], s51 offen offset:2048 sc1
    buffer_load_dwordx4 v[224:227], v1, s[12:15], s50 offen offset:2048 sc1
    buffer_load_dwordx4 v[212:215], v1, s[12:15], s51 offen offset:3072 sc1
    buffer_load_dwordx4 v[228:231], v1, s[12:15], s50 offen offset:3072 sc1
    s_add_u32 s56, s56, 4096
    s_cmp_eq_u32 s56, s57
    s_cselect_b32 s56, 0, s56
    v_mfma_f32_16x16x32_bf16 v[8:11], v[104:107], v[120:123], v[8:11]
    v_mfma_f32_16x16x32_bf16 v[12:15], v[104:107], v[124:127], v[12:15]
    v_mfma_f32_16x16x32_bf16 v[16:19], v[104:107], v[128:131], v[16:19]
    v_mfma_f32_16x16x32_bf16 v[20:23], v[104:107], v[132:135], v[20:23]
    v_mfma_f32_16x16x32_bf16 v[24:27], v[108:111], v[120:123], v[24:27]
    v_mfma_f32_16x16x32_bf16 v[28:31], v[108:111], v[124:127], v[28:31]
    v_mfma_f32_16x16x32_bf16 v[32:35], v[108:111], v[128:131], v[32:35]
    v_mfma_f32_16x16x32_bf16 v[36:39], v[108:111], v[132:135], v[36:39]
    v_mfma_f32_16x16x32_bf16 v[40:43], v[112:115], v[120:123], v[40:43]
    v_mfma_f32_16x16x32_bf16 v[44:47], v[112:115], v[124:127], v[44:47]
    v_mfma_f32_16x16x32_bf16 v[48:51], v[112:115], v[128:131], v[48:51]
    v_mfma_f32_16x16x32_bf16 v[52:55], v[112:115], v[132:135], v[52:55]
    v_mfma_f32_16x16x32_bf16 v[56:59], v[116:119], v[120:123], v[56:59]
    v_mfma_f32_16x16x32_bf16 v[60:63], v[116:119], v[124:127], v[60:63]
    v_mfma_f32_16x16x32_bf16 v[64:67], v[116:119], v[128:131], v[64:67]
    v_mfma_f32_16x16x32_bf16 v[68:71], v[116:119], v[132:135], v[68:71]
    s_waitcnt vmcnt(16)
    s_add_u32 s51, s49, s56
    s_add_u32 s50, s48, s56
    buffer_load_dwordx4 v[72:75], v1, s[12:15], s51 offen offset:0 sc1
    buffer_load_dwordx4 v[88:91], v1, s[12:15], s50 offen offset:0 sc1
    buffer_load_dwordx4 v[76:79], v1, s[12:15], s51 offen offset:1024 sc1
    buffer_load_dwordx4 v[92:95], v1, s[12:15], s50 offen offset:1024 sc1
    buffer_load_dwordx4 v[80:83], v1, s[12:15], s51 offen offset:2048 sc1
    buffer_load_dwordx4 v[96:99], v1, s[12:15], s50 offen offset:2048 sc1
    buffer_load_dwordx4 v[84:87], v1, s[12:15], s51 offen offset:3072 sc1
    buffer_load_dwordx4 v[100:103], v1, s[12:15], s50 offen offset:3072 sc1
    s_add_u32 s56, s56, 4096
    s_cmp_eq_u32 s56, s57
    s_cselect_b32 s56, 0, s56
    v_mfma_f32_16x16x32_bf16 v[8:11], v[136:139], v[152:155], v[8:11]
    v_mfma_f32_16x16x32_bf16 v[12:15], v[136:139], v[156:159], v[12:15]
    v_mfma_f32_16x16x32_bf16 v[16:19], v[136:139], v[160:163], v[16:19]
    v_mfma_f32_16x16x32_bf16 v[20:23], v[136:139], v[164:167], v[20:23]
    v_mfma_f32_16x16x32_bf16 v[24:27], v[140:143], v[152:155], v[24:27]
    v_mfma_f32_16x16x32_bf16 v[28:31], v[140:143], v[156:159], v[28:31]
    v_mfma_f32_16x16x32_bf16 v[32:35], v[140:143], v[160:163], v[32:35]
    v_mfma_f32_16x16x32_bf16 v[36:39], v[140:143], v[164:167], v[36:39]
    v_mfma_f32_16x16x32_bf16 v[40:43], v[144:147], v[152:155], v[40:43]
    v_mfma_f32_16x16x32_bf16 v[44:47], v[144:147], v[156:159], v[44:47]
    v_mfma_f32_16x16x32_bf16 v[48:51], v[144:147], v[160:163], v[48:51]
    v_mfma_f32_16x16x32_bf16 v[52:55], v[144:147], v[164:167], v[52:55]
    v_mfma_f32_16x16x32_bf16 v[56:59], v[148:151], v[152:155], v[56:59]
    v_mfma_f32_16x16x32_bf16 v[60:63], v[148:151], v[156:159], v[60:63]
    v_mfma_f32_16x16x32_bf16 v[64:67], v[148:151], v[160:163], v[64:67]
    v_mfma_f32_16x16x32_bf16 v[68:71], v[148:151], v[164:167], v[68:71]
    s_waitcnt vmcnt(16)
    s_mov_b64 exec, 1
    ds_add_u32 v246, v247 offset:36
    s_mov_b64 exec, -1
    v_mfma_f32_16x16x32_bf16 v[8:11], v[168:171], v[184:187], v[8:11]
    v_mfma_f32_16x16x32_bf16 v[12:15], v[168:171], v[188:191], v[12:15]
    v_mfma_f32_16x16x32_bf16 v[16:19], v[168:171], v[192:195], v[16:19]
    v_mfma_f32_16x16x32_bf16 v[20:23], v[168:171], v[196:199], v[20:23]
    v_mfma_f32_16x16x32_bf16 v[24:27], v[172:175], v[184:187], v[24:27]
    v_mfma_f32_16x16x32_bf16 v[28:31], v[172:175], v[188:191], v[28:31]
    v_mfma_f32_16x16x32_bf16 v[32:35], v[172:175], v[192:195], v[32:35]
    v_mfma_f32_16x16x32_bf16 v[36:39], v[172:175], v[196:199], v[36:39]
    v_mfma_f32_16x16x32_bf16 v[40:43], v[176:179], v[184:187], v[40:43]
    v_mfma_f32_16x16x32_bf16 v[44:47], v[176:179], v[188:191], v[44:47]
    v_mfma_f32_16x16x32_bf16 v[48:51], v[176:179], v[192:195], v[48:51]
    v_mfma_f32_16x16x32_bf16 v[52:55], v[176:179], v[196:199], v[52:55]
    v_mfma_f32_16x16x32_bf16 v[56:59], v[180:183], v[184:187], v[56:59]
    v_mfma_f32_16x16x32_bf16 v[60:63], v[180:183], v[188:191], v[60:63]
    v_mfma_f32_16x16x32_bf16 v[64:67], v[180:183], v[192:195], v[64:67]
    v_mfma_f32_16x16x32_bf16 v[68:71], v[180:183], v[196:199], v[68:71]
    s_waitcnt vmcnt(8)
    v_mfma_f32_16x16x32_bf16 v[8:11], v[200:203], v[216:219], v[8:11]
    v_mfma_f32_16x16x32_bf16 v[12:15], v[200:203], v[220:223], v[12:15]
    v_mfma_f32_16x16x32_bf16 v[16:19], v[200:203], v[224:227], v[16:19]
    v_mfma_f32_16x16x32_bf16 v[20:23], v[200:203], v[228:231], v[20:23]
    v_mfma_f32_16x16x32_bf16 v[24:27], v[204:207], v[216:219], v[24:27]
    v_mfma_f32_16x16x32_bf16 v[28:31], v[204:207], v[220:223], v[28:31]
    v_mfma_f32_16x16x32_bf16 v[32:35], v[204:207], v[224:227], v[32:35]
    v_mfma_f32_16x16x32_bf16 v[36:39], v[204:207], v[228:231], v[36:39]
    v_mfma_f32_16x16x32_bf16 v[40:43], v[208:211], v[216:219], v[40:43]
    v_mfma_f32_16x16x32_bf16 v[44:47], v[208:211], v[220:223], v[44:47]
    v_mfma_f32_16x16x32_bf16 v[48:51], v[208:211], v[224:227], v[48:51]
    v_mfma_f32_16x16x32_bf16 v[52:55], v[208:211], v[228:231], v[52:55]
    v_mfma_f32_16x16x32_bf16 v[56:59], v[212:215], v[216:219], v[56:59]
    v_mfma_f32_16x16x32_bf16 v[60:63], v[212:215], v[220:223], v[60:63]
    v_mfma_f32_16x16x32_bf16 v[64:67], v[212:215], v[224:227], v[64:67]
    v_mfma_f32_16x16x32_bf16 v[68:71], v[212:215], v[228:231], v[68:71]
    s_cmp_eq_u32 s42, 3
    s_cbranch_scc1 G2_DONE
    s_waitcnt vmcnt(0)
    v_mfma_f32_16x16x32_bf16 v[8:11], v[72:75], v[88:91], v[8:11]
    v_mfma_f32_16x16x32_bf16 v[12:15], v[72:75], v[92:95], v[12:15]
    v_mfma_f32_16x16x32_bf16 v[16:19], v[72:75], v[96:99], v[16:19]
    v_mfma_f32_16x16x32_bf16 v[20:23], v[72:75], v[100:103], v[20:23]
    v_mfma_f32_16x16x32_bf16 v[24:27], v[76:79], v[88:91], v[24:27]
    v_mfma_f32_16x16x32_bf16 v[28:31], v[76:79], v[92:95], v[28:31]
    v_mfma_f32_16x16x32_bf16 v[32:35], v[76:79], v[96:99], v[32:35]
    v_mfma_f32_16x16x32_bf16 v[36:39], v[76:79], v[100:103], v[36:39]
    v_mfma_f32_16x16x32_bf16 v[40:43], v[80:83], v[88:91], v[40:43]
    v_mfma_f32_16x16x32_bf16 v[44:47], v[80:83], v[92:95], v[44:47]
    v_mfma_f32_16x16x32_bf16 v[48:51], v[80:83], v[96:99], v[48:51]
    v_mfma_f32_16x16x32_bf16 v[52:55], v[80:83], v[100:103], v[52:55]
    v_mfma_f32_16x16x32_bf16 v[56:59], v[84:87], v[88:91], v[56:59]
    v_mfma_f32_16x16x32_bf16 v[60:63], v[84:87], v[92:95], v[60:63]
    v_mfma_f32_16x16x32_bf16 v[64:67], v[84:87], v[96:99], v[64:67]
    v_mfma_f32_16x16x32_bf16 v[68:71], v[84:87], v[100:103], v[68:71]
G2_DONE:
    s_mul_i32 s3, s42, 17408
    s_add_u32 s3, s3, 76800
    v_mul_u32_u24 v5, 272, v3
    v_lshl_add_u32 v5, v4, 4, v5
    v_add_u32 v5, s3, v5
    s_mov_b32 s63, 0
G2_P2:
    s_sleep 1
    ds_read_b32 v248, v246 offset:28
    s_add_u32 s63, s63, 1
    s_waitcnt lgkmcnt(0)
    v_readfirstlane_b32 s62, v248
    s_lshr_b32 s97, s63, 22
    s_lshl_b32 s97, s97, 8
    s_add_u32 s62, s62, s97
    s_cmp_lt_u32 s62, 4
    s_cbranch_scc1 G2_P2
    ds_write_b128 v5, v[8:11] offset:0
    ds_write_b128 v5, v[12:15] offset:4352
    ds_write_b128 v5, v[16:19] offset:8704
    ds_write_b128 v5, v[20:23] offset:13056
    ds_write_b128 v5, v[24:27] offset:64
    ds_write_b128 v5, v[28:31] offset:4416
    ds_write_b128 v5, v[32:35] offset:8768
    ds_write_b128 v5, v[36:39] offset:13120
    ds_write_b128 v5, v[40:43] offset:128
    ds_write_b128 v5, v[44:47] offset:4480
    ds_write_b128 v5, v[48:51] offset:8832
    ds_write_b128 v5, v[52:55] offset:13184
    s_waitcnt lgkmcnt(4)
    ds_write_b128 v5, v[56:59] offset:192
    ds_write_b128 v5, v[60:63] offset:4544
    ds_write_b128 v5, v[64:67] offset:8896
    ds_write_b128 v5, v[68:71] offset:13248
    s_branch KF_FINAL
KF_SIDE:
    s_sub_u32 s43, s42, 4
    s_setprio 3
    s_lshr_b32 s44, s43, 1
    s_and_b32 s75, s2, 7
    s_lshl_b32 s75, s75, 5
    s_lshr_b32 s3, s2, 3
    s_add_u32 s100, s75, s3
    s_lshl_b32 s45, s100, 1
    s_add_u32 s45, s45, s44
    s_and_b32 s46, s43, 1
    v_lshrrev_b32 v5, 2, v2
    v_and_b32 v6, 3, v2
    v_lshlrev_b32 v7, 10, v5
    v_lshl_add_u32 v7, v6, 4, v7
    v_add_u32 v8, 15360, v7
    s_lshl_b32 s3, s45, 8
    s_lshl_b32 s47, s46, 7
    s_add_u32 s47, s47, s3
    v_lshlrev_b32 v9, 1, v2
    v_lshlrev_b32 v10, 2, v2
    s_lshl_b32 s48, s45, 1
    v_mov_b32 v11, s48
    v_lshlrev_b32 v16, 4, v2
    v_mov_b32 v27, 0
    s_lshl_b32 s49, s2, 13
    s_lshl_b32 s50, s43, 11
    s_add_u32 s49, s49, s50
    s_lshl_b32 s54, s40, 7
    s_lshl_b32 s50, s43, 5
    s_add_u32 s54, s54, s50
    s_lshl_b32 s54, s54, 10
    s_lshl_b32 s50, s41, 6
    s_add_u32 s54, s54, s50
    s_lshl_b32 s51, s43, 12
    s_add_u32 s51, s51, 122880
    s_lshr_b32 s52, s2, 2
    s_and_b32 s53, s2, 3
    s_lshl_b32 s55, s52, 15
    s_lshl_b32 s50, s53, 8
    s_add_u32 s55, s55, s50
    s_lshl_b32 s50, s43, 6
    s_add_u32 s55, s55, s50
    s_add_u32 s50, s51, 2048
    s_memrealtime s[76:77]
    s_waitcnt lgkmcnt(0)
    s_mov_b64 s[4:5], s[16:17]
    s_mov_b32 s6, 2097152
    s_mov_b32 s7, 0x00020000
    s_mov_b64 s[92:93], s[80:81]
    s_mov_b32 s94, 256
    s_mov_b32 s95, 0x00020000
    s_or_b32 s76, s76, 1
    s_add_u32 s56, s2, s43
    s_cmp_lg_u32 s56, 0
    s_cbranch_scc1 S_NOTOK
    v_mov_b32 v14, s76
    v_mov_b32 v15, s77
    s_mov_b64 exec, 1
    buffer_store_dwordx2 v[14:15], v27, s[92:95], 0 offen sc1
    s_mov_b64 exec, -1
S_NOTOK:
    buffer_load_dwordx4 v[160:163], v16, s[4:7], s49 offen
    buffer_load_dwordx4 v[164:167], v16, s[4:7], s49 offen offset:1024
    s_mov_b32 m0, s51
    s_mov_b64 s[8:9], s[36:37]
    s_mov_b32 s10, 1409024
    s_mov_b32 s11, 0x00020000
    buffer_load_dwordx4 v7, s[4:7], s54 offen lds
    buffer_load_dwordx4 v8, s[4:7], s54 offen offset:1024 lds
    s_mov_b32 m0, s50
    s_mov_b64 s[64:65], s[18:19]
    s_mov_b32 s66, 131072
    s_mov_b32 s67, 0x00020000
    buffer_load_dwordx4 v7, s[8:11], s55 offen lds
    buffer_load_dwordx4 v8, s[8:11], s55 offen offset:1024 lds
    s_mov_b64 s[68:69], s[20:21]
    s_mov_b32 s70, 131072
    s_mov_b32 s71, 0x00020000
    s_mov_b64 s[72:73], s[22:23]
    s_mov_b32 s74, 131072
    s_mov_b32 s75, 0x00020000
    s_mov_b64 s[84:85], s[24:25]
    s_mov_b32 s86, 131072
    s_mov_b32 s87, 0x00020000
    s_mov_b64 s[88:89], s[26:27]
    s_mov_b32 s90, 1024
    s_mov_b32 s91, 0x00020000
    s_mov_b64 s[12:13], s[82:83]
    s_mov_b32 s14, 23068672
    s_mov_b32 s15, 0x00020000
    buffer_load_ushort v20, v9, s[64:67], s47 offen
    buffer_load_ushort v21, v9, s[68:71], s47 offen
    buffer_load_ushort v22, v9, s[72:75], s47 offen
    buffer_load_ushort v23, v9, s[84:87], s47 offen
    buffer_load_dword v24, v10, s[72:75], s3 offen
    buffer_load_dword v25, v10, s[84:87], s3 offen
    buffer_load_ushort v26, v11, s[88:91], 0 offen
    s_barrier
    v_lshrrev_b32 v12, 3, v3
    v_and_b32 v13, 7, v3
    v_lshl_add_u32 v12, v12, 7, v13
    v_cvt_f32_u32 v28, v12
    v_lshrrev_b32 v12, 2, v3
    v_and_b32 v13, 3, v3
    v_lshlrev_b32 v12, 7, v12
    v_lshl_add_u32 v12, v13, 1, v12
    v_add_u32 v12, 256, v12
    v_lshrrev_b32 v13, 1, v3
    v_and_b32 v14, 1, v3
    v_lshlrev_b32 v13, 7, v13
    v_lshl_add_u32 v13, v14, 2, v13
    v_cmp_gt_u32 vcc, 8, v3
    s_nop 1
    v_cndmask_b32 v12, v13, v12, vcc
    v_cvt_f32_u32 v29, v12
    v_lshlrev_b32 v12, 7, v3
    v_add_u32 v12, 0x400, v12
    v_cvt_f32_u32 v30, v12
    v_lshlrev_b32 v12, 3, v3
    v_cvt_f32_u32 v31, v12
    v_subrev_u32 v12, 0x100, v0
    v_or_b32 v13, 16, v12
    v_ffbh_u32 v13, v13
    v_sub_u32 v13, 27, v13
    v_lshlrev_b32 v14, v13, v247
    v_sub_u32 v15, 0, v14
    v_lshrrev_b32 v14, 1, v14
    v_subrev_u32 v14, 1, v14
    v_max_i32 v14, 0, v14
    v_lshl_add_u32 v14, v12, 3, v14
    v_sub_u32 v17, 3, v13
    v_lshlrev_b32 v18, 8, v13
    v_add_u32 v18, 0x20000, v18
    v_min_u32 v19, 1, v13
    v_lshlrev_b32 v52, 3, v12
    v_add_u32 v53, 0, v52
    v_bfe_u32 v53, v53, v13, v19
    v_add3_u32 v53, v53, v14, 0
    v_and_b32 v53, v53, v15
    v_lshrrev_b32 v54, 7, v53
    v_lshlrev_b32 v54, v17, v54
    v_bfe_u32 v55, v53, v13, v17
    v_add_u32 v54, v54, v55
    v_bfe_u32 v55, v53, 3, 4
    v_lshl_add_u32 v55, v55, 1, v18
    v_lshl_add_u32 v32, v54, 5, v55
    v_add_u32 v53, 1, v52
    v_bfe_u32 v53, v53, v13, v19
    v_add3_u32 v53, v53, v14, 1
    v_and_b32 v53, v53, v15
    v_lshrrev_b32 v54, 7, v53
    v_lshlrev_b32 v54, v17, v54
    v_bfe_u32 v55, v53, v13, v17
    v_add_u32 v54, v54, v55
    v_bfe_u32 v55, v53, 3, 4
    v_lshl_add_u32 v55, v55, 1, v18
    v_lshl_add_u32 v33, v54, 5, v55
    v_add_u32 v53, 2, v52
    v_bfe_u32 v53, v53, v13, v19
    v_add3_u32 v53, v53, v14, 2
    v_and_b32 v53, v53, v15
    v_lshrrev_b32 v54, 7, v53
    v_lshlrev_b32 v54, v17, v54
    v_bfe_u32 v55, v53, v13, v17
    v_add_u32 v54, v54, v55
    v_bfe_u32 v55, v53, 3, 4
    v_lshl_add_u32 v55, v55, 1, v18
    v_lshl_add_u32 v34, v54, 5, v55
    v_add_u32 v53, 3, v52
    v_bfe_u32 v53, v53, v13, v19
    v_add3_u32 v53, v53, v14, 3
    v_and_b32 v53, v53, v15
    v_lshrrev_b32 v54, 7, v53
    v_lshlrev_b32 v54, v17, v54
    v_bfe_u32 v55, v53, v13, v17
    v_add_u32 v54, v54, v55
    v_bfe_u32 v55, v53, 3, 4
    v_lshl_add_u32 v55, v55, 1, v18
    v_lshl_add_u32 v35, v54, 5, v55
    v_add_u32 v53, 4, v52
    v_bfe_u32 v53, v53, v13, v19
    v_add3_u32 v53, v53, v14, 4
    v_and_b32 v53, v53, v15
    v_lshrrev_b32 v54, 7, v53
    v_lshlrev_b32 v54, v17, v54
    v_bfe_u32 v55, v53, v13, v17
    v_add_u32 v54, v54, v55
    v_bfe_u32 v55, v53, 3, 4
    v_lshl_add_u32 v55, v55, 1, v18
    v_lshl_add_u32 v36, v54, 5, v55
    v_add_u32 v53, 5, v52
    v_bfe_u32 v53, v53, v13, v19
    v_add3_u32 v53, v53, v14, 5
    v_and_b32 v53, v53, v15
    v_lshrrev_b32 v54, 7, v53
    v_lshlrev_b32 v54, v17, v54
    v_bfe_u32 v55, v53, v13, v17
    v_add_u32 v54, v54, v55
    v_bfe_u32 v55, v53, 3, 4
    v_lshl_add_u32 v55, v55, 1, v18
    v_lshl_add_u32 v37, v54, 5, v55
    v_add_u32 v53, 6, v52
    v_bfe_u32 v53, v53, v13, v19
    v_add3_u32 v53, v53, v14, 6
    v_and_b32 v53, v53, v15
    v_lshrrev_b32 v54, 7, v53
    v_lshlrev_b32 v54, v17, v54
    v_bfe_u32 v55, v53, v13, v17
    v_add_u32 v54, v54, v55
    v_bfe_u32 v55, v53, 3, 4
    v_lshl_add_u32 v55, v55, 1, v18
    v_lshl_add_u32 v38, v54, 5, v55
    v_add_u32 v53, 7, v52
    v_bfe_u32 v53, v53, v13, v19
    v_add3_u32 v53, v53, v14, 7
    v_and_b32 v53, v53, v15
    v_lshrrev_b32 v54, 7, v53
    v_lshlrev_b32 v54, v17, v54
    v_bfe_u32 v55, v53, v13, v17
    v_add_u32 v54, v54, v55
    v_bfe_u32 v55, v53, 3, 4
    v_lshl_add_u32 v55, v55, 1, v18
    v_lshl_add_u32 v39, v54, 5, v55
    v_bfe_u32 v52, v2, 2, 2
    v_lshl_add_u32 v13, v4, 3, v52
    v_lshlrev_b32 v13, 6, v13
    v_lshl_add_u32 v13, v6, 3, v13
    v_add_u32 v13, s51, v13
    v_lshl_add_u32 v14, v4, 2, v52
    v_lshlrev_b32 v14, 6, v14
    v_lshl_add_u32 v14, v6, 3, v14
    v_add_u32 v14, s50, v14
    s_lshl_b32 s48, s40, 4
    s_lshl_b32 s49, s43, 2
    s_add_u32 s48, s48, s49
    s_lshl_b32 s48, s48, 13
    s_lshl_b32 s49, s41, 9
    s_add_u32 s48, s48, s49
    s_add_u32 s48, s48, 8388608
    v_lshlrev_b32 v15, 13, v4
    v_lshl_add_u32 v15, v3, 4, v15
    s_lshl_b32 s49, s53, 1
    s_add_u32 s49, s49, s44
    s_mul_i32 s49, s49, 43
    s_add_u32 s49, s49, s52
    s_lshl_b32 s49, s49, 2
    s_lshl_b32 s56, s46, 1
    s_add_u32 s49, s49, s56
    s_lshl_b32 s49, s49, 10
    s_add_u32 s49, s49, 6291456
    s_waitcnt vmcnt(7)
    buffer_load_dwordx2 v[202:203], v27, s[92:95], 0 offen sc1
    ds_read_b64_tr_b16 v[52:53], v13 offset:0
    ds_read_b64_tr_b16 v[54:55], v13 offset:256
    ds_read_b64_tr_b16 v[56:57], v13 offset:32
    ds_read_b64_tr_b16 v[58:59], v13 offset:288
    ds_read_b64_tr_b16 v[60:61], v14 offset:0
    ds_read_b64_tr_b16 v[62:63], v14 offset:1024
    ds_read_b64_tr_b16 v[64:65], v14 offset:32
    ds_read_b64_tr_b16 v[66:67], v14 offset:1056
    v_lshlrev_b32 v168, 16, v160
    v_and_b32 v169, 0xffff0000, v160
    v_lshlrev_b32 v170, 16, v161
    v_and_b32 v171, 0xffff0000, v161
    v_lshlrev_b32 v172, 16, v162
    v_and_b32 v173, 0xffff0000, v162
    v_lshlrev_b32 v174, 16, v163
    v_and_b32 v175, 0xffff0000, v163
    v_lshlrev_b32 v176, 16, v164
    v_and_b32 v177, 0xffff0000, v164
    v_lshlrev_b32 v178, 16, v165
    v_and_b32 v179, 0xffff0000, v165
    v_lshlrev_b32 v180, 16, v166
    v_and_b32 v181, 0xffff0000, v166
    v_lshlrev_b32 v182, 16, v167
    v_and_b32 v183, 0xffff0000, v167
    s_waitcnt lgkmcnt(4)
    buffer_store_dwordx4 v[52:55], v15, s[12:15], s48 offen sc1
    buffer_store_dwordx4 v[56:59], v15, s[12:15], s48 offen offset:256 sc1
    s_cmp_ge_u32 s2, 172
    s_cselect_b32 s49, 0x7f000000, s49
    s_waitcnt lgkmcnt(0)
    buffer_store_dwordx4 v[60:63], v16, s[12:15], s49 offen sc1
    buffer_store_dwordx4 v[64:67], v16, s[12:15], s49 offen offset:1024 sc1
    v_pk_add_f32 v[184:185], v[168:169], v[170:171]
    v_pk_add_f32 v[186:187], v[172:173], v[174:175]
    v_pk_add_f32 v[188:189], v[176:177], v[178:179]
    v_pk_add_f32 v[190:191], v[180:181], v[182:183]
    v_pk_add_f32 v[184:185], v[184:185], v[186:187]
    v_pk_add_f32 v[188:189], v[188:189], v[190:191]
    v_add_f32 v192, v184, v185
    v_add_f32 v193, v188, v189
    s_nop 0
    v_add_f32_dpp v192, v192, v192 row_ror:8 row_mask:0xf bank_mask:0xf
    v_add_f32_dpp v193, v193, v193 row_ror:8 row_mask:0xf bank_mask:0xf
    s_nop 0
    v_add_f32_dpp v192, v192, v192 row_ror:4 row_mask:0xf bank_mask:0xf
    v_add_f32_dpp v193, v193, v193 row_ror:4 row_mask:0xf bank_mask:0xf
    s_nop 0
    v_add_f32_dpp v192, v192, v192 row_ror:2 row_mask:0xf bank_mask:0xf
    v_add_f32_dpp v193, v193, v193 row_ror:2 row_mask:0xf bank_mask:0xf
    s_nop 0
    v_add_f32_dpp v192, v192, v192 row_ror:1 row_mask:0xf bank_mask:0xf
    v_add_f32_dpp v193, v193, v193 row_ror:1 row_mask:0xf bank_mask:0xf
    v_readlane_b32 s54, v192, 0
    v_readlane_b32 s55, v192, 16
    v_readlane_b32 s56, v192, 32
    v_readlane_b32 s57, v192, 48
    v_readlane_b32 s58, v193, 0
    v_readlane_b32 s59, v193, 16
    v_readlane_b32 s60, v193, 32
    v_readlane_b32 s61, v193, 48
    v_mov_b32 v192, s54
    v_mov_b32 v193, s58
    v_add_f32 v192, s55, v192
    v_add_f32 v193, s59, v193
    v_add_f32 v192, s56, v192
    v_add_f32 v193, s60, v193
    v_add_f32 v192, s57, v192
    v_add_f32 v193, s61, v193
    v_mul_f32 v192, 0xbb000000, v192
    v_mul_f32 v198, 0xbb000000, v193
    v_pk_add_f32 v[168:169], v[168:169], v[192:193] op_sel_hi:[1,0]
    v_pk_add_f32 v[170:171], v[170:171], v[192:193] op_sel_hi:[1,0]
    v_pk_add_f32 v[172:173], v[172:173], v[192:193] op_sel_hi:[1,0]
    v_pk_add_f32 v[174:175], v[174:175], v[192:193] op_sel_hi:[1,0]
    v_pk_add_f32 v[176:177], v[176:177], v[198:199] op_sel_hi:[1,0]
    v_pk_add_f32 v[178:179], v[178:179], v[198:199] op_sel_hi:[1,0]
    v_pk_add_f32 v[180:181], v[180:181], v[198:199] op_sel_hi:[1,0]
    v_pk_add_f32 v[182:183], v[182:183], v[198:199] op_sel_hi:[1,0]
    v_pk_mul_f32 v[184:185], v[168:169], v[168:169]
    v_pk_fma_f32 v[184:185], v[170:171], v[170:171], v[184:185]
    v_pk_fma_f32 v[184:185], v[172:173], v[172:173], v[184:185]
    v_pk_fma_f32 v[184:185], v[174:175], v[174:175], v[184:185]
    v_pk_mul_f32 v[188:189], v[176:177], v[176:177]
    v_pk_fma_f32 v[188:189], v[178:179], v[178:179], v[188:189]
    v_pk_fma_f32 v[188:189], v[180:181], v[180:181], v[188:189]
    v_pk_fma_f32 v[188:189], v[182:183], v[182:183], v[188:189]
    v_add_f32 v194, v184, v185
    v_add_f32 v195, v188, v189
    s_nop 0
    v_add_f32_dpp v194, v194, v194 row_ror:8 row_mask:0xf bank_mask:0xf
    v_add_f32_dpp v195, v195, v195 row_ror:8 row_mask:0xf bank_mask:0xf
    s_nop 0
    v_add_f32_dpp v194, v194, v194 row_ror:4 row_mask:0xf bank_mask:0xf
    v_add_f32_dpp v195, v195, v195 row_ror:4 row_mask:0xf bank_mask:0xf
    s_nop 0
    v_add_f32_dpp v194, v194, v194 row_ror:2 row_mask:0xf bank_mask:0xf
    v_add_f32_dpp v195, v195, v195 row_ror:2 row_mask:0xf bank_mask:0xf
    s_nop 0
    v_add_f32_dpp v194, v194, v194 row_ror:1 row_mask:0xf bank_mask:0xf
    v_add_f32_dpp v195, v195, v195 row_ror:1 row_mask:0xf bank_mask:0xf
    v_readlane_b32 s54, v194, 0
    v_readlane_b32 s55, v194, 16
    v_readlane_b32 s56, v194, 32
    v_readlane_b32 s57, v194, 48
    v_readlane_b32 s58, v195, 0
    v_readlane_b32 s59, v195, 16
    v_readlane_b32 s60, v195, 32
    v_readlane_b32 s61, v195, 48
    v_mov_b32 v194, s54
    v_mov_b32 v195, s58
    v_add_f32 v194, s55, v194
    v_add_f32 v195, s59, v195
    v_add_f32 v194, s56, v194
    v_add_f32 v195, s60, v195
    v_add_f32 v194, s57, v194
    v_add_f32 v195, s61, v195
    v_mul_f32 v194, 0x3b000000, v194
    v_cvt_pk_bf16_f32 v196, v194, v194
    v_lshlrev_b32 v194, 16, v196
    v_add_f32 v194, 0x3727c5ac, v194
    v_cvt_pk_bf16_f32 v196, v194, v194
    v_lshlrev_b32 v194, 16, v196
    v_sqrt_f32 v194, v194
    s_nop 0
    v_cvt_pk_bf16_f32 v200, v192, v194
    v_mul_f32 v195, 0x3b000000, v195
    v_cvt_pk_bf16_f32 v196, v195, v195
    v_lshlrev_b32 v195, 16, v196
    v_add_f32 v195, 0x3727c5ac, v195
    v_cvt_pk_bf16_f32 v196, v195, v195
    v_lshlrev_b32 v195, 16, v196
    v_sqrt_f32 v195, v195
    s_nop 0
    v_cvt_pk_bf16_f32 v201, v198, v195
    s_waitcnt vmcnt(4)
    s_mov_b32 s63, 0
S_TOK:
    v_readfirstlane_b32 s76, v202
    v_readfirstlane_b32 s77, v203
    s_add_u32 s63, s63, 1
    s_cmp_gt_u32 s63, 0x10000
    s_cbranch_scc1 S_TOKX
    s_cmp_lg_u32 s76, 0
    s_cbranch_scc1 S_TOKX
    buffer_load_dwordx2 v[202:203], v27, s[92:95], 0 offen sc1
    s_waitcnt vmcnt(0)
    s_branch S_TOK
S_TOKX:
    s_lshl_b32 s3, s2, 6
    s_lshl_b32 s49, s43, 4
    s_add_u32 s3, s3, s49
    s_add_u32 s3, s3, 16777216
    v_mov_b32 v196, 154432
    s_mov_b64 exec, 1
    buffer_store_dwordx4 v[200:203], v27, s[12:15], s3 offen sc1
    ds_write_b64 v196, v[202:203]
    ds_add_u32 v246, v247 offset:52
    s_mov_b64 exec, -1
    v_lshlrev_b32 v20, 16, v20
    v_lshlrev_b32 v21, 16, v21
    v_lshlrev_b32 v22, 16, v22
    v_lshlrev_b32 v23, 16, v23
    v_lshlrev_b32 v26, 16, v26
    v_mul_f32 v26, 0x3fb8aa3b, v26
    v_mul_f32 v20, 0x3fb8aa3b, v20
    v_exp_f32 v26, v26
    v_exp_f32 v20, v20
    v_lshlrev_b32 v18, 16, v24
    v_and_b32 v13, 0xffff0000, v24
    v_lshlrev_b32 v14, 16, v25
    v_and_b32 v15, 0xffff0000, v25
    v_max3_f32 v18, |v18|, |v13|, |v14|
    v_max_f32 v18, |v15|, v18
    v_cvt_pk_bf16_f32 v13, v26, v26
    v_lshlrev_b32 v26, 16, v13
    v_cvt_pk_bf16_f32 v13, v20, v20
    v_lshlrev_b32 v20, 16, v13
    v_max_f32_dpp v18, v18, v18 row_ror:8 row_mask:0xf bank_mask:0xf
    s_nop 1
    v_max_f32_dpp v18, v18, v18 row_ror:4 row_mask:0xf bank_mask:0xf
    s_nop 1
    v_max_f32_dpp v18, v18, v18 row_ror:2 row_mask:0xf bank_mask:0xf
    s_nop 1
    v_max_f32_dpp v18, v18, v18 row_ror:1 row_mask:0xf bank_mask:0xf
    s_nop 0
    v_readlane_b32 s56, v18, 0
    v_readlane_b32 s57, v18, 16
    v_readlane_b32 s58, v18, 32
    v_readlane_b32 s59, v18, 48
    s_max_u32 s56, s56, s57
    s_nop 0
    s_max_u32 s58, s58, s59
    s_max_u32 s56, s56, s58
    v_frexp_exp_i32_f32 v18, s56
    v_sub_u32 v13, 0, v18
    v_mul_f32 v20, v20, v26
    v_mul_f32 v20, 0xbfb8aa3b, v20
    v_mul_f32 v21, v21, v26
    s_mov_b32 s56, 0x3e22f983
    s_mov_b32 s57, 0x31dc9c88
    v_mul_f32 v14, s56, v21
    v_fma_f32 v15, v21, s56, -v14
    v_fma_f32 v15, v21, s57, v15
    v_and_b32 v19, 0xffffff00, v14
    v_sub_f32 v14, v14, v19
    v_add_f32 v15, v15, v14
    v_ldexp_f32 v22, v22, v13
    v_ldexp_f32 v23, v23, v13
    v_add_f32 v26, v26, v26
    v_ldexp_f32 v26, v26, v18
    s_mul_i32 s3, s43, 1280
    s_add_u32 s3, s3, 139264
    v_add_u32 v18, s3, v10
    ds_write_b32 v18, v20
    ds_write_b32 v18, v19 offset:256
    ds_write_b32 v18, v15 offset:512
    ds_write_b32 v18, v22 offset:768
    ds_write_b32 v18, v23 offset:1024
    v_readfirstlane_b32 s96, v26
    v_lshlrev_b32 v17, 4, v4
    v_add_u32 v17, s3, v17
    v_mov_b32 v40, 0
    v_mov_b32 v41, 0
    v_mov_b32 v42, 0
    v_mov_b32 v43, 0
    v_mov_b32 v44, 0
    v_mov_b32 v45, 0
    v_mov_b32 v46, 0
    v_mov_b32 v47, 0
    v_mov_b32 v48, 0
    v_mov_b32 v49, 0
    v_mov_b32 v50, 0
    v_mov_b32 v51, 0
    v_lshlrev_b32 v19, 13, v12
    v_lshlrev_b32 v14, 4, v12
    s_lshr_b32 s47, s100, 4
    v_mov_b32 v20, s47
    v_lshrrev_b32 v15, 3, v3
    v_lshrrev_b32 v21, 2, v20
    v_lshl_add_u32 v15, v21, 1, v15
    v_and_b32 v21, 7, v3
    v_and_b32 v22, 3, v20
    v_lshl_add_u32 v21, v22, 3, v21
    v_lshl_add_u32 v15, v21, 3, v15
    v_lshlrev_b32 v15, 7, v15
    s_mov_b32 s47, 0
    s_lshl_b32 s3, s2, 7
    s_add_u32 s3, s3, 16908288
    s_setprio 1
S_KG:
    ds_read_b128 v[52:55], v17 offset:0
    ds_read_b128 v[56:59], v17 offset:256
    ds_read_b128 v[60:63], v17 offset:512
    ds_read_b128 v[64:67], v17 offset:768
    ds_read_b128 v[68:71], v17 offset:1024
    v_add_u32 v17, 64, v17
    s_waitcnt lgkmcnt(0)
    v_mul_f32 v88, v52, v28
    v_mul_f32 v89, v56, v28
    v_mul_f32 v94, v52, v29
    v_mul_f32 v95, v56, v29
    v_mul_f32 v100, v52, v30
    v_mul_f32 v101, v56, v30
    v_mul_f32 v106, v52, v31
    v_mul_f32 v107, v56, v31
    v_exp_f32 v88, v88
    v_fract_f32 v89, v89
    v_fmac_f32 v89, v60, v28
    v_exp_f32 v94, v94
    v_fract_f32 v95, v95
    v_fmac_f32 v95, v60, v29
    v_exp_f32 v100, v100
    v_fract_f32 v101, v101
    v_fmac_f32 v101, v60, v30
    v_exp_f32 v106, v106
    v_fract_f32 v107, v107
    v_fmac_f32 v107, v60, v31
    v_sin_f32 v90, v89
    v_mul_f32 v91, v64, v88
    v_cos_f32 v89, v89
    v_mul_f32 v92, v68, v88
    v_sin_f32 v96, v95
    v_mul_f32 v97, v64, v94
    v_cos_f32 v95, v95
    v_mul_f32 v98, v68, v94
    v_sin_f32 v102, v101
    v_mul_f32 v103, v64, v100
    v_cos_f32 v101, v101
    v_mul_f32 v104, v68, v100
    v_sin_f32 v108, v107
    v_cos_f32 v107, v107
    v_mul_f32 v88, v91, v89
    v_mul_f32 v93, v91, v90
    v_mul_f32 v94, v97, v95
    v_mul_f32 v99, v97, v96
    v_mul_f32 v100, v103, v101
    v_mul_f32 v105, v103, v102
    v_mul_f32 v107, v106, v107
    v_mul_f32 v108, v106, v108
    v_fma_f32 v88, -v92, v90, v88
    v_fma_f32 v93, -v92, v89, -v93
    v_fma_f32 v94, -v98, v96, v94
    v_fma_f32 v99, -v98, v95, -v99
    v_fma_f32 v100, -v104, v102, v100
    v_fma_f32 v105, -v104, v101, -v105
    v_cvt_pk_f16_f32 v84, v107, v108
    v_cvt_pk_f16_f32 v72, v88, v93
    v_cvt_pk_f16_f32 v76, v94, v99
    v_cvt_pk_f16_f32 v80, v100, v105
    v_mul_f32 v88, v53, v28
    v_mul_f32 v89, v57, v28
    v_mul_f32 v94, v53, v29
    v_mul_f32 v95, v57, v29
    v_mul_f32 v100, v53, v30
    v_mul_f32 v101, v57, v30
    v_mul_f32 v106, v53, v31
    v_mul_f32 v107, v57, v31
    v_exp_f32 v88, v88
    v_fract_f32 v89, v89
    v_fmac_f32 v89, v61, v28
    v_exp_f32 v94, v94
    v_fract_f32 v95, v95
    v_fmac_f32 v95, v61, v29
    v_exp_f32 v100, v100
    v_fract_f32 v101, v101
    v_fmac_f32 v101, v61, v30
    v_exp_f32 v106, v106
    v_fract_f32 v107, v107
    v_fmac_f32 v107, v61, v31
    v_sin_f32 v90, v89
    v_mul_f32 v91, v65, v88
    v_cos_f32 v89, v89
    v_mul_f32 v92, v69, v88
    v_sin_f32 v96, v95
    v_mul_f32 v97, v65, v94
    v_cos_f32 v95, v95
    v_mul_f32 v98, v69, v94
    v_sin_f32 v102, v101
    v_mul_f32 v103, v65, v100
    v_cos_f32 v101, v101
    v_mul_f32 v104, v69, v100
    v_sin_f32 v108, v107
    v_cos_f32 v107, v107
    v_mul_f32 v88, v91, v89
    v_mul_f32 v93, v91, v90
    v_mul_f32 v94, v97, v95
    v_mul_f32 v99, v97, v96
    v_mul_f32 v100, v103, v101
    v_mul_f32 v105, v103, v102
    v_mul_f32 v107, v106, v107
    v_mul_f32 v108, v106, v108
    v_fma_f32 v88, -v92, v90, v88
    v_fma_f32 v93, -v92, v89, -v93
    v_fma_f32 v94, -v98, v96, v94
    v_fma_f32 v99, -v98, v95, -v99
    v_fma_f32 v100, -v104, v102, v100
    v_fma_f32 v105, -v104, v101, -v105
    v_cvt_pk_f16_f32 v85, v107, v108
    v_cvt_pk_f16_f32 v73, v88, v93
    v_cvt_pk_f16_f32 v77, v94, v99
    v_cvt_pk_f16_f32 v81, v100, v105
    v_mul_f32 v88, v54, v28
    v_mul_f32 v89, v58, v28
    v_mul_f32 v94, v54, v29
    v_mul_f32 v95, v58, v29
    v_mul_f32 v100, v54, v30
    v_mul_f32 v101, v58, v30
    v_mul_f32 v106, v54, v31
    v_mul_f32 v107, v58, v31
    v_exp_f32 v88, v88
    v_fract_f32 v89, v89
    v_fmac_f32 v89, v62, v28
    v_exp_f32 v94, v94
    v_fract_f32 v95, v95
    v_fmac_f32 v95, v62, v29
    v_exp_f32 v100, v100
    v_fract_f32 v101, v101
    v_fmac_f32 v101, v62, v30
    v_exp_f32 v106, v106
    v_fract_f32 v107, v107
    v_fmac_f32 v107, v62, v31
    v_sin_f32 v90, v89
    v_mul_f32 v91, v66, v88
    v_cos_f32 v89, v89
    v_mul_f32 v92, v70, v88
    v_sin_f32 v96, v95
    v_mul_f32 v97, v66, v94
    v_cos_f32 v95, v95
    v_mul_f32 v98, v70, v94
    v_sin_f32 v102, v101
    v_mul_f32 v103, v66, v100
    v_cos_f32 v101, v101
    v_mul_f32 v104, v70, v100
    v_sin_f32 v108, v107
    v_cos_f32 v107, v107
    v_mul_f32 v88, v91, v89
    v_mul_f32 v93, v91, v90
    v_mul_f32 v94, v97, v95
    v_mul_f32 v99, v97, v96
    v_mul_f32 v100, v103, v101
    v_mul_f32 v105, v103, v102
    v_mul_f32 v107, v106, v107
    v_mul_f32 v108, v106, v108
    v_fma_f32 v88, -v92, v90, v88
    v_fma_f32 v93, -v92, v89, -v93
    v_fma_f32 v94, -v98, v96, v94
    v_fma_f32 v99, -v98, v95, -v99
    v_fma_f32 v100, -v104, v102, v100
    v_fma_f32 v105, -v104, v101, -v105
    v_cvt_pk_f16_f32 v86, v107, v108
    v_cvt_pk_f16_f32 v74, v88, v93
    v_cvt_pk_f16_f32 v78, v94, v99
    v_cvt_pk_f16_f32 v82, v100, v105
    v_mul_f32 v88, v55, v28
    v_mul_f32 v89, v59, v28
    v_mul_f32 v94, v55, v29
    v_mul_f32 v95, v59, v29
    v_mul_f32 v100, v55, v30
    v_mul_f32 v101, v59, v30
    v_mul_f32 v106, v55, v31
    v_mul_f32 v107, v59, v31
    v_exp_f32 v88, v88
    v_fract_f32 v89, v89
    v_fmac_f32 v89, v63, v28
    v_exp_f32 v94, v94
    v_fract_f32 v95, v95
    v_fmac_f32 v95, v63, v29
    v_exp_f32 v100, v100
    v_fract_f32 v101, v101
    v_fmac_f32 v101, v63, v30
    v_exp_f32 v106, v106
    v_fract_f32 v107, v107
    v_fmac_f32 v107, v63, v31
    v_sin_f32 v90, v89
    v_mul_f32 v91, v67, v88
    v_cos_f32 v89, v89
    v_mul_f32 v92, v71, v88
    v_sin_f32 v96, v95
    v_mul_f32 v97, v67, v94
    v_cos_f32 v95, v95
    v_mul_f32 v98, v71, v94
    v_sin_f32 v102, v101
    v_mul_f32 v103, v67, v100
    v_cos_f32 v101, v101
    v_mul_f32 v104, v71, v100
    v_sin_f32 v108, v107
    v_cos_f32 v107, v107
    v_mul_f32 v88, v91, v89
    v_mul_f32 v93, v91, v90
    v_mul_f32 v94, v97, v95
    v_mul_f32 v99, v97, v96
    v_mul_f32 v100, v103, v101
    v_mul_f32 v105, v103, v102
    v_mul_f32 v107, v106, v107
    v_mul_f32 v108, v106, v108
    v_fma_f32 v88, -v92, v90, v88
    v_fma_f32 v93, -v92, v89, -v93
    v_fma_f32 v94, -v98, v96, v94
    v_fma_f32 v99, -v98, v95, -v99
    v_fma_f32 v100, -v104, v102, v100
    v_fma_f32 v105, -v104, v101, -v105
    v_cvt_pk_f16_f32 v87, v107, v108
    v_cvt_pk_f16_f32 v75, v88, v93
    v_cvt_pk_f16_f32 v79, v94, v99
    v_cvt_pk_f16_f32 v83, v100, v105
    v_mfma_f32_16x16x32_f16 v[40:43], v[72:75], v[84:87], v[40:43]
    v_mfma_f32_16x16x32_f16 v[44:47], v[76:79], v[84:87], v[44:47]
    v_mfma_f32_16x16x32_f16 v[48:51], v[80:83], v[84:87], v[48:51]
    s_add_u32 s47, s47, 1
    s_cmp_eq_u32 s47, 1
    s_cbranch_scc1 S_E1
    s_cmp_eq_u32 s47, 3
    s_cbranch_scc1 S_E3
    s_cmp_lt_u32 s47, 4
    s_cbranch_scc1 S_KG
    s_branch S_KGX
S_E1:
    s_waitcnt vmcnt(0)
    s_mov_b64 exec, 1
    ds_add_rtn_u32 v248, v246, v247 offset:48
    s_waitcnt lgkmcnt(0)
    s_mov_b64 exec, -1
    v_readfirstlane_b32 s62, v248
    s_nop 1
    s_cmp_lg_u32 s62, 3
    s_cbranch_scc1 S_KG
    v_mov_b32 v20, s76
    v_mov_b32 v21, s77
    v_mov_b32 v22, s76
    v_mov_b32 v23, s77
    s_mov_b64 exec, 0xff
    buffer_store_dwordx4 v[20:23], v16, s[12:15], s3 offen sc1
    s_mov_b64 exec, -1
    s_branch S_KG
S_E3:
    s_mov_b32 s3, 16908288
    s_mov_b32 s63, 0
S_FA:
    buffer_load_dwordx2 v[88:89], v15, s[12:15], s3 offen sc1
    s_add_u32 s63, s63, 1
    s_waitcnt vmcnt(0)
    v_cmp_ne_u64 vcc, s[76:77], v[88:89]
    s_cmp_gt_u32 s63, 0x10000
    s_cbranch_scc1 S_FA_X
    s_cmp_eq_u64 vcc, 0
    s_cbranch_scc1 S_FA_X
    s_sleep 2
    s_branch S_FA
S_FA_X:
    s_lshl_b32 s48, s100, 5
    s_add_u32 s48, s48, 8388608
    s_mov_b32 s49, 16777216
    s_mov_b32 s50, 16781312
    s_mov_b32 s51, 16785408
    s_mov_b32 s52, 16789504
    buffer_load_dwordx4 v[128:131], v19, s[12:15], s48 offen sc1
    buffer_load_dwordx4 v[132:135], v19, s[12:15], s48 offen offset:16 sc1
    buffer_load_dwordx4 v[160:163], v14, s[12:15], s49 offen sc1
    buffer_load_dwordx4 v[164:167], v14, s[12:15], s50 offen sc1
    buffer_load_dwordx4 v[168:171], v14, s[12:15], s51 offen sc1
    buffer_load_dwordx4 v[172:175], v14, s[12:15], s52 offen sc1
    s_branch S_KG
S_KGX:
    s_mul_i32 s3, s44, 4608
    s_add_u32 s3, s3, 144384
    v_add_u32 v17, s3, v16
    s_add_u32 s3, s3, 3072
    v_lshlrev_b32 v18, 7, v4
    v_lshl_add_u32 v18, v3, 1, v18
    v_add_u32 v18, s3, v18
    s_cmp_eq_u32 s46, 0
    s_cbranch_scc1 S_R1
    ds_write_b128 v17, v[40:43] offset:0
    ds_write_b128 v17, v[44:47] offset:1024
    ds_write_b128 v17, v[48:51] offset:2048
    s_waitcnt lgkmcnt(0)
S_R1:
    s_mov_b32 s63, 0
S_P8:
    s_sleep 1
    ds_read_b32 v248, v246 offset:48
    s_add_u32 s63, s63, 1
    s_waitcnt lgkmcnt(0)
    v_readfirstlane_b32 s62, v248
    s_lshr_b32 s97, s63, 22
    s_lshl_b32 s97, s97, 8
    s_add_u32 s62, s62, s97
    s_cmp_lt_u32 s62, 4
    s_cbranch_scc1 S_P8
    v_lshlrev_b32 v20, 3, v12
    v_add_u32 v20, 122880, v20
    v_lshrrev_b32 v21, 7, v12
    v_lshlrev_b32 v21, 12, v21
    v_lshl_add_u32 v21, v12, 5, v21
    v_add_u32 v21, 122880, v21
    s_mov_b32 s63, 0
S_SP:
    s_waitcnt vmcnt(0)
    v_cmp_ne_u64 vcc, s[76:77], v[162:163]
    v_cmp_ne_u64 s[60:61], s[76:77], v[166:167]
    s_nop 1
    s_or_b64 vcc, vcc, s[60:61]
    v_cmp_ne_u64 s[60:61], s[76:77], v[170:171]
    s_nop 1
    s_or_b64 vcc, vcc, s[60:61]
    v_cmp_ne_u64 s[60:61], s[76:77], v[174:175]
    s_nop 1
    s_or_b64 vcc, vcc, s[60:61]
    s_add_u32 s63, s63, 1
    s_cmp_gt_u32 s63, 0x10000
    s_cbranch_scc1 S_SPX
    s_cmp_eq_u64 vcc, 0
    s_cbranch_scc1 S_SPX
    s_sleep 8
    buffer_load_dwordx4 v[160:163], v14, s[12:15], s49 offen sc1
    buffer_load_dwordx4 v[164:167], v14, s[12:15], s50 offen sc1
    buffer_load_dwordx4 v[168:171], v14, s[12:15], s51 offen sc1
    buffer_load_dwordx4 v[172:175], v14, s[12:15], s52 offen sc1
    s_branch S_SP
S_SPX:
    ds_write_b64 v20, v[160:161] offset:0
    ds_write_b64 v20, v[164:165] offset:2048
    ds_write_b64 v20, v[168:169] offset:8192
    ds_write_b64 v20, v[172:173] offset:10240
    s_waitcnt lgkmcnt(0)
    s_mov_b64 exec, 1
    ds_add_u32 v246, v247 offset:4
    s_mov_b64 exec, -1
    s_cmp_lg_u32 s46, 0
    s_cbranch_scc1 S_R2
    s_mov_b32 s63, 0
S_P1:
    s_sleep 1
    ds_read_b32 v248, v246 offset:4
    s_add_u32 s63, s63, 1
    s_waitcnt lgkmcnt(0)
    v_readfirstlane_b32 s62, v248
    s_lshr_b32 s97, s63, 22
    s_lshl_b32 s97, s97, 8
    s_add_u32 s62, s62, s97
    s_cmp_lt_u32 s62, 4
    s_cbranch_scc1 S_P1
    ds_read_b128 v[52:55], v17 offset:0
    ds_read_b128 v[56:59], v17 offset:1024
    ds_read_b128 v[60:63], v17 offset:2048
    s_waitcnt lgkmcnt(0)
    v_add_f32 v40, v40, v52
    v_add_f32 v41, v41, v53
    v_add_f32 v42, v42, v54
    v_add_f32 v43, v43, v55
    v_add_f32 v44, v44, v56
    v_add_f32 v45, v45, v57
    v_add_f32 v46, v46, v58
    v_add_f32 v47, v47, v59
    v_add_f32 v48, v48, v60
    v_add_f32 v49, v49, v61
    v_add_f32 v50, v50, v62
    v_add_f32 v51, v51, v63
    v_cvt_pk_f16_f32 v40, v40, v41
    v_cvt_pk_f16_f32 v42, v42, v43
    v_cvt_pk_f16_f32 v44, v44, v45
    v_cvt_pk_f16_f32 v46, v46, v47
    v_cvt_pk_f16_f32 v48, v48, v49
    v_cvt_pk_f16_f32 v50, v50, v51
    ds_write_b16 v18, v40 offset:0
    ds_write_b16_d16_hi v18, v40 offset:32
    ds_write_b16 v18, v42 offset:64
    ds_write_b16_d16_hi v18, v42 offset:96
    ds_write_b16 v18, v44 offset:512
    ds_write_b16_d16_hi v18, v44 offset:544
    ds_write_b16 v18, v46 offset:576
    ds_write_b16_d16_hi v18, v46 offset:608
    ds_write_b16 v18, v48 offset:1024
    ds_write_b16_d16_hi v18, v48 offset:1056
    ds_write_b16 v18, v50 offset:1088
    ds_write_b16_d16_hi v18, v50 offset:1120
    s_waitcnt lgkmcnt(0)
    s_mov_b64 exec, 1
    ds_add_u32 v246, v247 offset:8
    s_mov_b64 exec, -1
S_R2:
    v_lshlrev_b32 v13, 4, v12
    v_add_u32 v13, 126976, v13
    s_mov_b32 s63, 0
S_P2:
    s_sleep 1
    ds_read_b32 v248, v246 offset:8
    s_add_u32 s63, s63, 1
    s_waitcnt lgkmcnt(0)
    v_readfirstlane_b32 s62, v248
    s_lshr_b32 s97, s63, 22
    s_lshl_b32 s97, s97, 8
    s_add_u32 s62, s62, s97
    s_cmp_lt_u32 s62, 2
    s_cbranch_scc1 S_P2
    ds_read_u16 v52, v32 offset:16384
    ds_read_u16_d16_hi v56, v33 offset:16384
    ds_read_u16 v53, v34 offset:16384
    ds_read_u16_d16_hi v57, v35 offset:16384
    ds_read_u16 v54, v36 offset:16384
    ds_read_u16_d16_hi v58, v37 offset:16384
    ds_read_u16 v55, v38 offset:16384
    ds_read_u16_d16_hi v59, v39 offset:16384
    ds_read_u16 v60, v32 offset:20992
    ds_read_u16_d16_hi v64, v33 offset:20992
    ds_read_u16 v61, v34 offset:20992
    ds_read_u16_d16_hi v65, v35 offset:20992
    ds_read_u16 v62, v36 offset:20992
    ds_read_u16_d16_hi v66, v37 offset:20992
    ds_read_u16 v63, v38 offset:20992
    s_waitcnt lgkmcnt(8)
    ds_read_u16_d16_hi v67, v39 offset:20992
    s_waitcnt lgkmcnt(8)
    v_or_b32 v52, v52, v56
    v_or_b32 v53, v53, v57
    v_or_b32 v54, v54, v58
    v_or_b32 v55, v55, v59
    ds_write_b128 v13, v[52:55] offset:0
    s_waitcnt lgkmcnt(1)
    v_or_b32 v60, v60, v64
    v_or_b32 v61, v61, v65
    v_or_b32 v62, v62, v66
    v_or_b32 v63, v63, v67
    ds_write_b128 v13, v[60:63] offset:8192
    ds_read_b128 v[160:163], v21
    ds_read_b128 v[164:167], v21 offset:16
    s_waitcnt lgkmcnt(0)
    s_mov_b64 exec, 1
    ds_add_u32 v246, v247 offset:12
    s_mov_b64 exec, -1
    s_waitcnt vmcnt(0)
    v_lshlrev_b32 v136, 16, v160
    v_and_b32 v144, 0xffff0000, v160
    v_lshlrev_b32 v137, 16, v161
    v_and_b32 v145, 0xffff0000, v161
    v_lshlrev_b32 v138, 16, v162
    v_and_b32 v146, 0xffff0000, v162
    v_lshlrev_b32 v139, 16, v163
    v_and_b32 v147, 0xffff0000, v163
    v_lshlrev_b32 v140, 16, v164
    v_and_b32 v148, 0xffff0000, v164
    v_lshlrev_b32 v141, 16, v165
    v_and_b32 v149, 0xffff0000, v165
    v_lshlrev_b32 v142, 16, v166
    v_and_b32 v150, 0xffff0000, v166
    v_lshlrev_b32 v143, 16, v167
    v_and_b32 v151, 0xffff0000, v167
    v_rcp_f32 v144, v144
    v_rcp_f32 v145, v145
    v_rcp_f32 v146, v146
    v_rcp_f32 v147, v147
    v_rcp_f32 v148, v148
    v_rcp_f32 v149, v149
    v_rcp_f32 v150, v150
    v_rcp_f32 v151, v151
    v_lshlrev_b32 v96, 16, v128
    v_and_b32 v97, 0xffff0000, v128
    v_lshlrev_b32 v98, 16, v129
    v_and_b32 v99, 0xffff0000, v129
    v_lshlrev_b32 v100, 16, v130
    v_and_b32 v101, 0xffff0000, v130
    v_lshlrev_b32 v102, 16, v131
    v_and_b32 v103, 0xffff0000, v131
    v_pk_add_f32 v[96:97], v[96:97], v[136:137]
    v_pk_add_f32 v[98:99], v[98:99], v[138:139]
    v_pk_add_f32 v[100:101], v[100:101], v[140:141]
    v_pk_add_f32 v[102:103], v[102:103], v[142:143]
    v_cvt_pk_bf16_f32 v128, v96, v97
    v_cvt_pk_bf16_f32 v129, v98, v99
    v_cvt_pk_bf16_f32 v130, v100, v101
    v_cvt_pk_bf16_f32 v131, v102, v103
    v_lshlrev_b32 v96, 16, v128
    v_and_b32 v97, 0xffff0000, v128
    v_lshlrev_b32 v98, 16, v129
    v_and_b32 v99, 0xffff0000, v129
    v_lshlrev_b32 v100, 16, v130
    v_and_b32 v101, 0xffff0000, v130
    v_lshlrev_b32 v102, 16, v131
    v_and_b32 v103, 0xffff0000, v131
    v_pk_mul_f32 v[96:97], v[96:97], v[144:145]
    v_pk_mul_f32 v[98:99], v[98:99], v[146:147]
    v_pk_mul_f32 v[100:101], v[100:101], v[148:149]
    v_pk_mul_f32 v[102:103], v[102:103], v[150:151]
    v_cvt_pk_bf16_f32 v128, v96, v97
    v_cvt_pk_bf16_f32 v129, v98, v99
    v_cvt_pk_bf16_f32 v130, v100, v101
    v_cvt_pk_bf16_f32 v131, v102, v103
    v_lshlrev_b32 v96, 16, v128
    v_and_b32 v97, 0xffff0000, v128
    v_lshlrev_b32 v98, 16, v129
    v_and_b32 v99, 0xffff0000, v129
    v_lshlrev_b32 v100, 16, v130
    v_and_b32 v101, 0xffff0000, v130
    v_lshlrev_b32 v102, 16, v131
    v_and_b32 v103, 0xffff0000, v131
    v_cvt_pk_f16_f32 v131, v97, v96
    v_cvt_pk_f16_f32 v130, v99, v98
    v_cvt_pk_f16_f32 v129, v101, v100
    v_cvt_pk_f16_f32 v128, v103, v102
    v_lshlrev_b32 v96, 16, v132
    v_and_b32 v97, 0xffff0000, v132
    v_lshlrev_b32 v98, 16, v133
    v_and_b32 v99, 0xffff0000, v133
    v_lshlrev_b32 v100, 16, v134
    v_and_b32 v101, 0xffff0000, v134
    v_lshlrev_b32 v102, 16, v135
    v_and_b32 v103, 0xffff0000, v135
    v_pk_add_f32 v[96:97], v[96:97], v[136:137]
    v_pk_add_f32 v[98:99], v[98:99], v[138:139]
    v_pk_add_f32 v[100:101], v[100:101], v[140:141]
    v_pk_add_f32 v[102:103], v[102:103], v[142:143]
    v_cvt_pk_bf16_f32 v132, v96, v97
    v_cvt_pk_bf16_f32 v133, v98, v99
    v_cvt_pk_bf16_f32 v134, v100, v101
    v_cvt_pk_bf16_f32 v135, v102, v103
    v_lshlrev_b32 v96, 16, v132
    v_and_b32 v97, 0xffff0000, v132
    v_lshlrev_b32 v98, 16, v133
    v_and_b32 v99, 0xffff0000, v133
    v_lshlrev_b32 v100, 16, v134
    v_and_b32 v101, 0xffff0000, v134
    v_lshlrev_b32 v102, 16, v135
    v_and_b32 v103, 0xffff0000, v135
    v_pk_mul_f32 v[96:97], v[96:97], v[144:145]
    v_pk_mul_f32 v[98:99], v[98:99], v[146:147]
    v_pk_mul_f32 v[100:101], v[100:101], v[148:149]
    v_pk_mul_f32 v[102:103], v[102:103], v[150:151]
    v_cvt_pk_bf16_f32 v132, v96, v97
    v_cvt_pk_bf16_f32 v133, v98, v99
    v_cvt_pk_bf16_f32 v134, v100, v101
    v_cvt_pk_bf16_f32 v135, v102, v103
    v_lshlrev_b32 v96, 16, v132
    v_and_b32 v97, 0xffff0000, v132
    v_lshlrev_b32 v98, 16, v133
    v_and_b32 v99, 0xffff0000, v133
    v_lshlrev_b32 v100, 16, v134
    v_and_b32 v101, 0xffff0000, v134
    v_lshlrev_b32 v102, 16, v135
    v_and_b32 v103, 0xffff0000, v135
    v_cvt_pk_f16_f32 v135, v97, v96
    v_cvt_pk_f16_f32 v134, v99, v98
    v_cvt_pk_f16_f32 v133, v101, v100
    v_cvt_pk_f16_f32 v132, v103, v102
    s_setprio 2
    v_lshrrev_b32 v5, 3, v0
    v_and_b32 v6, 7, v0
    v_lshlrev_b32 v7, 10, v5
    v_lshl_add_u32 v7, v6, 4, v7
    v_lshlrev_b32 v8, 4, v6
    s_lshl_b32 s44, s78, 16
    s_lshl_b32 s45, s79, 7
    s_add_u32 s44, s44, s45
    s_lshr_b32 s46, s78, 4
    s_lshl_b32 s46, s46, 12
    s_lshl_b32 s3, s78, 8
    s_add_u32 s46, s46, s3
    s_add_u32 s46, s46, 122880
    v_lshlrev_b32 v9, 2, v5
    v_add_u32 v9, s46, v9
    s_mov_b64 s[8:9], s[28:29]
    s_mov_b32 s10, 1024
    s_mov_b32 s11, 0x00020000
    ds_read_b32 v240, v9
    v_mov_b32 v56, 0
    v_mov_b32 v57, 0
    v_mov_b32 v58, 0
    v_mov_b32 v59, 0
    v_lshrrev_b32 v20, 4, v12
    v_mul_u32_u24 v20, 1280, v20
    v_lshl_add_u32 v20, v3, 4, v20
    v_add_u32 v20, 66560, v20
    v_bfe_u32 v21, v12, 5, 1
    v_mul_u32_u24 v21, 33280, v21
    v_and_b32 v22, 31, v12
    v_lshl_add_u32 v21, v22, 4, v21
    v_cmp_gt_u32 vcc, 0x80, v12
    s_nop 1
    v_cndmask_b32 v20, v21, v20, vcc
    v_add_u32 v21, 4, v12
    v_and_b32 v22, 1, v21
    v_bfe_u32 v23, v21, 1, 2
    v_lshl_add_u32 v22, v22, 2, v23
    v_lshlrev_b32 v22, 4, v22
    v_lshl_add_u32 v21, v21, 7, v22
    v_xor_b32 v88, 0, v21
    v_xor_b32 v89, 16, v21
    v_xor_b32 v90, 32, v21
    v_xor_b32 v91, 48, v21
    v_xor_b32 v92, 64, v21
    v_xor_b32 v93, 80, v21
    v_xor_b32 v94, 96, v21
    v_xor_b32 v95, 112, v21
    v_and_b32 v22, 3, v12
    v_mul_u32_u24 v22, 1280, v22
    v_lshrrev_b32 v23, 2, v12
    v_lshl_add_u32 v22, v23, 4, v22
    v_add_u32 v22, 66816, v22
    v_cmp_eq_u32 s[56:57], 0, v12
    v_subrev_u32 v13, 16, v13
    s_mov_b32 s63, 0
C_P0:
    s_sleep 1
    ds_read_b32 v248, v246 offset:12
    s_add_u32 s63, s63, 1
    s_waitcnt lgkmcnt(0)
    v_readfirstlane_b32 s62, v248
    s_lshr_b32 s97, s63, 22
    s_lshl_b32 s97, s97, 8
    s_add_u32 s62, s62, s97
    s_cmp_lt_u32 s62, 4
    s_cbranch_scc1 C_P0
    ds_read_b128 v[96:99], v13 offset:0
    v_mov_b32 v100, v52
    v_mov_b32 v101, v53
    v_mov_b32 v102, v54
    v_mov_b32 v103, v55
    ds_read_b128 v[104:107], v13 offset:8192
    v_mov_b32 v108, v60
    v_mov_b32 v109, v61
    v_mov_b32 v110, v62
    v_mov_b32 v111, v63
    s_waitcnt lgkmcnt(0)
    v_cndmask_b32 v96, v96, 0, s[56:57]
    v_cndmask_b32 v97, v97, 0, s[56:57]
    v_cndmask_b32 v98, v98, 0, s[56:57]
    v_cndmask_b32 v99, v99, 0, s[56:57]
    v_alignbit_b32 v64, v97, v96, 16
    v_alignbit_b32 v65, v98, v97, 16
    v_alignbit_b32 v66, v99, v98, 16
    v_alignbit_b32 v67, v100, v99, 16
    v_alignbit_b32 v68, v101, v100, 16
    v_alignbit_b32 v69, v102, v101, 16
    v_alignbit_b32 v70, v103, v102, 16
    v_alignbit_b32 v72, v98, v97, 16
    v_mov_b32 v80, v97
    v_alignbit_b32 v73, v99, v98, 16
    v_mov_b32 v81, v98
    v_alignbit_b32 v74, v100, v99, 16
    v_mov_b32 v82, v99
    v_alignbit_b32 v75, v101, v100, 16
    v_mov_b32 v83, v100
    v_alignbit_b32 v76, v102, v101, 16
    v_mov_b32 v84, v101
    v_alignbit_b32 v77, v103, v102, 16
    v_mov_b32 v85, v102
    v_cndmask_b32 v104, v104, 0, s[56:57]
    v_cndmask_b32 v105, v105, 0, s[56:57]
    v_cndmask_b32 v106, v106, 0, s[56:57]
    v_cndmask_b32 v107, v107, 0, s[56:57]
    v_alignbit_b32 v112, v105, v104, 16
    v_alignbit_b32 v113, v106, v105, 16
    v_alignbit_b32 v114, v107, v106, 16
    v_alignbit_b32 v115, v108, v107, 16
    v_alignbit_b32 v116, v109, v108, 16
    v_alignbit_b32 v117, v110, v109, 16
    v_alignbit_b32 v118, v111, v110, 16
    v_alignbit_b32 v120, v106, v105, 16
    v_mov_b32 v152, v105
    v_alignbit_b32 v121, v107, v106, 16
    v_mov_b32 v153, v106
    v_alignbit_b32 v122, v108, v107, 16
    v_mov_b32 v154, v107
    v_alignbit_b32 v123, v109, v108, 16
    v_mov_b32 v155, v108
    v_alignbit_b32 v124, v110, v109, 16
    v_mov_b32 v156, v109
    v_alignbit_b32 v125, v111, v110, 16
    v_mov_b32 v157, v110
    s_lshr_b32 s48, s43, 1
    s_and_b32 s49, s43, 1
    v_and_b32 v16, 1, v4
    v_lshrrev_b32 v17, 1, v4
    v_lshl_add_u32 v16, v16, 1, v17
    v_lshlrev_b32 v17, 3, v16
    v_sub_u32 v17, v3, v17
    v_add_u32 v17, 32, v17
    v_and_b32 v18, 7, v17
    v_lshrrev_b32 v17, 3, v17
    s_lshl_b32 s3, s49, 2
    v_add_u32 v17, s3, v17
    s_mul_i32 s50, s48, 33280
    v_and_b32 v19, 1, v17
    v_bfe_u32 v23, v17, 1, 2
    v_lshl_add_u32 v19, v19, 2, v23
    v_xor_b32 v19, v19, v18
    v_lshlrev_b32 v19, 4, v19
    v_lshl_add_u32 v19, v17, 7, v19
    v_add_u32 v14, s50, v19
    v_add_u32 v17, 2, v17
    v_and_b32 v19, 1, v17
    v_bfe_u32 v23, v17, 1, 2
    v_lshl_add_u32 v19, v19, 2, v23
    v_xor_b32 v19, v19, v18
    v_lshlrev_b32 v19, 4, v19
    v_lshl_add_u32 v19, v17, 7, v19
    v_add_u32 v15, s50, v19
    s_mul_i32 s50, s48, 5120
    s_lshl_b32 s3, s49, 4
    s_sub_u32 s50, s50, s3
    s_add_u32 s50, s50, 66816
    v_mul_u32_u24 v19, 1280, v16
    v_lshl_add_u32 v19, v3, 4, v19
    v_add_u32 v13, s50, v19
    v_mov_b32 v24, 0
    v_mov_b32 v25, 0
    v_mov_b32 v26, 0
    v_mov_b32 v27, 0
    v_mov_b32 v28, 0
    v_mov_b32 v29, 0
    v_mov_b32 v30, 0
    v_mov_b32 v31, 0
    v_mov_b32 v32, 0
    v_mov_b32 v33, 0
    v_mov_b32 v34, 0
    v_mov_b32 v35, 0
    v_mov_b32 v36, 0
    v_mov_b32 v37, 0
    v_mov_b32 v38, 0
    v_mov_b32 v39, 0
    v_mov_b32 v40, 0
    v_mov_b32 v41, 0
    v_mov_b32 v42, 0
    v_mov_b32 v43, 0
    v_mov_b32 v44, 0
    v_mov_b32 v45, 0
    v_mov_b32 v46, 0
    v_mov_b32 v47, 0
    v_mov_b32 v48, 0
    v_mov_b32 v49, 0
    v_mov_b32 v50, 0
    v_mov_b32 v51, 0
    s_mov_b32 s63, 0
C_P1:
    s_sleep 1
    ds_read_b32 v248, v246 offset:0
    s_add_u32 s63, s63, 1
    s_waitcnt lgkmcnt(0)
    v_readfirstlane_b32 s62, v248
    s_lshr_b32 s97, s63, 22
    s_lshl_b32 s97, s97, 8
    s_add_u32 s62, s62, s97
    s_cmp_lt_u32 s62, 40
    s_cbranch_scc1 C_P1
    s_cmp_eq_u32 s43, 3
    s_cbranch_scc1 C_NOPAD
    ds_write_b128 v20, v[56:59]
C_NOPAD:
    ds_write_b128 v88, v[64:67] offset:0
    ds_write_b128 v89, v[80:83] offset:0
    ds_write_b128 v90, v[72:75] offset:0
    ds_write_b128 v91, v[98:101] offset:0
    ds_write_b128 v92, v[66:69] offset:0
    ds_write_b128 v93, v[82:85] offset:0
    ds_write_b128 v94, v[74:77] offset:0
    ds_write_b128 v95, v[100:103] offset:0
    ds_write_b128 v22, v[128:131] offset:0
    s_waitcnt lgkmcnt(4)
    ds_write_b128 v88, v[112:115] offset:33280
    ds_write_b128 v89, v[152:155] offset:33280
    ds_write_b128 v90, v[120:123] offset:33280
    ds_write_b128 v91, v[106:109] offset:33280
    ds_write_b128 v92, v[114:117] offset:33280
    ds_write_b128 v93, v[154:157] offset:33280
    ds_write_b128 v94, v[122:125] offset:33280
    ds_write_b128 v95, v[108:111] offset:33280
    ds_write_b128 v22, v[132:135] offset:5120
    v_mov_b32 v52, 0
    v_mov_b32 v53, 0
    v_mov_b32 v54, 0
    v_mov_b32 v55, 0
    s_waitcnt lgkmcnt(0)
    s_mov_b64 exec, 1
    ds_add_u32 v246, v247 offset:20
    s_mov_b64 exec, -1
    s_mov_b32 s63, 0
C_P2:
    ds_read_b32 v248, v246 offset:20
    s_add_u32 s63, s63, 1
    s_waitcnt lgkmcnt(0)
    v_readfirstlane_b32 s62, v248
    s_lshr_b32 s97, s63, 22
    s_lshl_b32 s97, s97, 8
    s_add_u32 s62, s62, s97
    s_cmp_lt_u32 s62, 4
    s_cbranch_scc1 C_P2
    ds_read_b128 v[64:67], v13 offset:0
    ds_read_b128 v[68:71], v13 offset:256
    ds_read_b128 v[72:75], v13 offset:512
    ds_read_b128 v[76:79], v13 offset:768
    ds_read_b128 v[80:83], v14 offset:0
    ds_read_b128 v[84:87], v15 offset:0
    ds_read_b128 v[88:91], v14 offset:8192
    ds_read_b128 v[92:95], v15 offset:8192
    ds_read_b128 v[96:99], v14 offset:16384
    ds_read_b128 v[100:103], v15 offset:16384
    ds_read_b128 v[104:107], v14 offset:24576
    ds_read_b128 v[108:111], v15 offset:24576
    v_subrev_u32 v13, 32, v13
    v_add_u32 v14, 0x400, v14
    v_add_u32 v15, 0x400, v15
    s_mov_b32 s50, 0
C_LOOP:
    s_waitcnt lgkmcnt(0)
    ds_read_b128 v[112:115], v13 offset:0
    ds_read_b128 v[116:119], v13 offset:256
    ds_read_b128 v[120:123], v13 offset:512
    ds_read_b128 v[124:127], v13 offset:768
    ds_read_b128 v[128:131], v14 offset:0
    ds_read_b128 v[132:135], v15 offset:0
    ds_read_b128 v[136:139], v14 offset:8192
    ds_read_b128 v[140:143], v15 offset:8192
    ds_read_b128 v[144:147], v14 offset:16384
    ds_read_b128 v[148:151], v15 offset:16384
    ds_read_b128 v[152:155], v14 offset:24576
    ds_read_b128 v[156:159], v15 offset:24576
    v_subrev_u32 v13, 32, v13
    v_add_u32 v14, 0x400, v14
    v_add_u32 v15, 0x400, v15
    v_mfma_f32_16x16x32_f16 v[24:27], v[80:83], v[64:67], v[24:27]
    v_mfma_f32_16x16x32_f16 v[32:35], v[80:83], v[68:71], v[32:35]
    v_mfma_f32_16x16x32_f16 v[40:43], v[80:83], v[72:75], v[40:43]
    v_mfma_f32_16x16x32_f16 v[48:51], v[80:83], v[76:79], v[48:51]
    v_mfma_f32_16x16x32_f16 v[28:31], v[84:87], v[64:67], v[28:31]
    v_mfma_f32_16x16x32_f16 v[36:39], v[84:87], v[68:71], v[36:39]
    v_mfma_f32_16x16x32_f16 v[44:47], v[84:87], v[72:75], v[44:47]
    v_mfma_f32_16x16x32_f16 v[52:55], v[84:87], v[76:79], v[52:55]
    v_mfma_f32_16x16x32_f16 v[32:35], v[88:91], v[64:67], v[32:35]
    v_mfma_f32_16x16x32_f16 v[40:43], v[88:91], v[68:71], v[40:43]
    v_mfma_f32_16x16x32_f16 v[48:51], v[88:91], v[72:75], v[48:51]
    v_mfma_f32_16x16x32_f16 v[36:39], v[92:95], v[64:67], v[36:39]
    v_mfma_f32_16x16x32_f16 v[44:47], v[92:95], v[68:71], v[44:47]
    v_mfma_f32_16x16x32_f16 v[52:55], v[92:95], v[72:75], v[52:55]
    v_mfma_f32_16x16x32_f16 v[40:43], v[96:99], v[64:67], v[40:43]
    v_mfma_f32_16x16x32_f16 v[48:51], v[96:99], v[68:71], v[48:51]
    v_mfma_f32_16x16x32_f16 v[44:47], v[100:103], v[64:67], v[44:47]
    v_mfma_f32_16x16x32_f16 v[52:55], v[100:103], v[68:71], v[52:55]
    v_mfma_f32_16x16x32_f16 v[48:51], v[104:107], v[64:67], v[48:51]
    v_mfma_f32_16x16x32_f16 v[52:55], v[108:111], v[64:67], v[52:55]
    s_waitcnt lgkmcnt(0)
    ds_read_b128 v[64:67], v13 offset:0
    ds_read_b128 v[68:71], v13 offset:256
    ds_read_b128 v[72:75], v13 offset:512
    ds_read_b128 v[76:79], v13 offset:768
    ds_read_b128 v[80:83], v14 offset:0
    ds_read_b128 v[84:87], v15 offset:0
    ds_read_b128 v[88:91], v14 offset:8192
    ds_read_b128 v[92:95], v15 offset:8192
    ds_read_b128 v[96:99], v14 offset:16384
    ds_read_b128 v[100:103], v15 offset:16384
    ds_read_b128 v[104:107], v14 offset:24576
    ds_read_b128 v[108:111], v15 offset:24576
    v_subrev_u32 v13, 32, v13
    v_add_u32 v14, 0x400, v14
    v_add_u32 v15, 0x400, v15
    v_mfma_f32_16x16x32_f16 v[24:27], v[128:131], v[112:115], v[24:27]
    v_mfma_f32_16x16x32_f16 v[32:35], v[128:131], v[116:119], v[32:35]
    v_mfma_f32_16x16x32_f16 v[40:43], v[128:131], v[120:123], v[40:43]
    v_mfma_f32_16x16x32_f16 v[48:51], v[128:131], v[124:127], v[48:51]
    v_mfma_f32_16x16x32_f16 v[28:31], v[132:135], v[112:115], v[28:31]
    v_mfma_f32_16x16x32_f16 v[36:39], v[132:135], v[116:119], v[36:39]
    v_mfma_f32_16x16x32_f16 v[44:47], v[132:135], v[120:123], v[44:47]
    v_mfma_f32_16x16x32_f16 v[52:55], v[132:135], v[124:127], v[52:55]
    v_mfma_f32_16x16x32_f16 v[32:35], v[136:139], v[112:115], v[32:35]
    v_mfma_f32_16x16x32_f16 v[40:43], v[136:139], v[116:119], v[40:43]
    v_mfma_f32_16x16x32_f16 v[48:51], v[136:139], v[120:123], v[48:51]
    v_mfma_f32_16x16x32_f16 v[36:39], v[140:143], v[112:115], v[36:39]
    v_mfma_f32_16x16x32_f16 v[44:47], v[140:143], v[116:119], v[44:47]
    v_mfma_f32_16x16x32_f16 v[52:55], v[140:143], v[120:123], v[52:55]
    v_mfma_f32_16x16x32_f16 v[40:43], v[144:147], v[112:115], v[40:43]
    v_mfma_f32_16x16x32_f16 v[48:51], v[144:147], v[116:119], v[48:51]
    v_mfma_f32_16x16x32_f16 v[44:47], v[148:151], v[112:115], v[44:47]
    v_mfma_f32_16x16x32_f16 v[52:55], v[148:151], v[116:119], v[52:55]
    v_mfma_f32_16x16x32_f16 v[48:51], v[152:155], v[112:115], v[48:51]
    v_mfma_f32_16x16x32_f16 v[52:55], v[156:159], v[112:115], v[52:55]
    s_add_u32 s50, s50, 1
    s_cmp_lt_u32 s50, 4
    s_cbranch_scc1 C_LOOP
    s_lshl_b32 s3, s43, 12
    s_add_u32 s3, s3, 76800
    v_lshlrev_b32 v16, 4, v2
    v_add_u32 v17, s3, v16
    s_xor_b32 s50, s43, 1
    s_lshl_b32 s50, s50, 12
    s_add_u32 s50, s50, 76800
    v_add_u32 v18, s50, v16
    s_waitcnt lgkmcnt(0)
    s_cmp_eq_u32 s49, 0
    s_cbranch_scc1 C_X
    v_swap_b32 v24, v40
    v_swap_b32 v25, v41
    v_swap_b32 v26, v42
    v_swap_b32 v27, v43
    v_swap_b32 v28, v44
    v_swap_b32 v29, v45
    v_swap_b32 v30, v46
    v_swap_b32 v31, v47
    v_swap_b32 v32, v48
    v_swap_b32 v33, v49
    v_swap_b32 v34, v50
    v_swap_b32 v35, v51
    v_swap_b32 v36, v52
    v_swap_b32 v37, v53
    v_swap_b32 v38, v54
    v_swap_b32 v39, v55
C_X:
    s_nop 1
    ds_write_b128 v17, v[40:43] offset:0
    ds_write_b128 v17, v[44:47] offset:1024
    ds_write_b128 v17, v[48:51] offset:2048
    ds_write_b128 v17, v[52:55] offset:3072
    s_waitcnt lgkmcnt(0)
    s_mov_b64 exec, 1
    ds_add_u32 v246, v247 offset:24
    s_mov_b64 exec, -1
    s_lshl_b32 s3, s100, 1
    s_add_u32 s3, s3, s48
    s_lshl_b32 s3, s3, 13
    s_lshl_b32 s51, s49, 12
    s_add_u32 s3, s3, s51
    s_add_u32 s3, s3, 12582912
    v_and_b32 v19, 3, v2
    v_lshrrev_b32 v20, 2, v2
    v_lshl_add_u32 v19, v19, 4, v20
    v_lshlrev_b32 v19, 2, v19
    s_mov_b32 s63, 0
C_P3:
    ds_read_b32 v248, v246 offset:24
    s_add_u32 s63, s63, 1
    s_waitcnt lgkmcnt(0)
    v_readfirstlane_b32 s62, v248
    s_lshr_b32 s97, s63, 22
    s_lshl_b32 s97, s97, 8
    s_add_u32 s62, s62, s97
    s_cmp_lt_u32 s62, 4
    s_cbranch_scc1 C_P3
    ds_read_b128 v[64:67], v18 offset:0
    ds_read_b128 v[68:71], v18 offset:1024
    ds_read_b128 v[72:75], v18 offset:2048
    ds_read_b128 v[76:79], v18 offset:3072
    s_waitcnt lgkmcnt(0)
    s_mov_b64 exec, 1
    ds_add_u32 v246, v247 offset:28
    s_mov_b64 exec, -1
    v_pk_add_f32 v[24:25], v[24:25], v[64:65]
    v_pk_add_f32 v[26:27], v[26:27], v[66:67]
    v_pk_add_f32 v[28:29], v[28:29], v[68:69]
    v_pk_add_f32 v[30:31], v[30:31], v[70:71]
    v_pk_add_f32 v[32:33], v[32:33], v[72:73]
    v_pk_add_f32 v[34:35], v[34:35], v[74:75]
    v_pk_add_f32 v[36:37], v[36:37], v[76:77]
    v_pk_add_f32 v[38:39], v[38:39], v[78:79]
    v_mul_f32 v24, s96, v24
    v_mul_f32 v25, s96, v25
    v_mul_f32 v26, s96, v26
    v_mul_f32 v27, s96, v27
    v_mul_f32 v28, s96, v28
    v_mul_f32 v29, s96, v29
    v_mul_f32 v30, s96, v30
    v_mul_f32 v31, s96, v31
    v_mul_f32 v32, s96, v32
    v_mul_f32 v33, s96, v33
    v_mul_f32 v34, s96, v34
    v_mul_f32 v35, s96, v35
    v_mul_f32 v36, s96, v36
    v_mul_f32 v37, s96, v37
    v_mul_f32 v38, s96, v38
    v_mul_f32 v39, s96, v39
    v_cvt_pk_bf16_f32 v26, v26, v27
    v_cvt_pk_bf16_f32 v27, v24, v25
    ds_bpermute_b32 v24, v19, v27
    ds_bpermute_b32 v25, v19, v26
    v_cvt_pk_bf16_f32 v30, v30, v31
    v_cvt_pk_bf16_f32 v31, v28, v29
    ds_bpermute_b32 v28, v19, v31
    ds_bpermute_b32 v29, v19, v30
    v_cvt_pk_bf16_f32 v34, v34, v35
    v_cvt_pk_bf16_f32 v35, v32, v33
    ds_bpermute_b32 v32, v19, v35
    ds_bpermute_b32 v33, v19, v34
    v_cvt_pk_bf16_f32 v38, v38, v39
    v_cvt_pk_bf16_f32 v39, v36, v37
    ds_bpermute_b32 v36, v19, v39
    ds_bpermute_b32 v37, v19, v38
    s_waitcnt lgkmcnt(0)
    v_mov_b32 v26, s76
    v_mov_b32 v27, s77
    buffer_store_dwordx4 v[24:27], v16, s[12:15], s3 offen offset:0 sc1
    v_mov_b32 v30, s76
    v_mov_b32 v31, s77
    buffer_store_dwordx4 v[28:31], v16, s[12:15], s3 offen offset:1024 sc1
    v_mov_b32 v34, s76
    v_mov_b32 v35, s77
    buffer_store_dwordx4 v[32:35], v16, s[12:15], s3 offen offset:2048 sc1
    v_mov_b32 v38, s76
    v_mov_b32 v39, s77
    buffer_store_dwordx4 v[36:39], v16, s[12:15], s3 offen offset:3072 sc1
    buffer_load_dwordx4 v[232:235], v7, s[4:7], s44 offen
    buffer_load_dwordx4 v[236:239], v8, s[8:11], s45 offen
    v_lshrrev_b32 v16, 4, v12
    v_lshlrev_b32 v16, 13, v16
    v_bfe_u32 v20, v3, 2, 1
    v_lshl_add_u32 v16, v20, 10, v16
    v_lshrrev_b32 v20, 3, v3
    v_lshl_add_u32 v16, v20, 6, v16
    v_and_b32 v20, 3, v3
    v_lshl_add_u32 v16, v20, 4, v16
    s_lshl_b32 s50, s79, 19
    s_lshr_b32 s51, s78, 3
    s_lshl_b32 s51, s51, 11
    s_add_u32 s50, s50, s51
    s_and_b32 s51, s78, 7
    s_lshl_b32 s51, s51, 7
    s_add_u32 s50, s50, s51
    s_add_u32 s50, s50, 12582912
    v_and_b32 v17, 7, v3
    v_xor_b32 v17, s43, v17
    v_lshlrev_b32 v17, 4, v17
    v_lshl_add_u32 v17, v4, 2, v17
    v_mul_u32_u24 v18, 1088, v3
    v_xor_b32 v20, 64, v17
    v_add_u32 v17, v17, v18
    v_add_u32 v18, v20, v18
    s_add_u32 s51, s50, 0x20000
    s_add_u32 s52, s50, 0x40000
    s_add_u32 s53, s50, 0x60000
    s_setprio 0
    s_waitcnt vmcnt(0)
    v_and_b32 v242, 0xffff0000, v240
    v_lshlrev_b32 v240, 16, v240
    v_rcp_f32 v242, v242
    v_lshlrev_b32 v96, 16, v232
    v_and_b32 v97, 0xffff0000, v232
    v_lshlrev_b32 v98, 16, v233
    v_and_b32 v99, 0xffff0000, v233
    v_lshlrev_b32 v100, 16, v234
    v_and_b32 v101, 0xffff0000, v234
    v_lshlrev_b32 v102, 16, v235
    v_and_b32 v103, 0xffff0000, v235
    v_lshlrev_b32 v112, 16, v236
    v_and_b32 v113, 0xffff0000, v236
    v_lshlrev_b32 v114, 16, v237
    v_and_b32 v115, 0xffff0000, v237
    v_lshlrev_b32 v116, 16, v238
    v_and_b32 v117, 0xffff0000, v238
    v_lshlrev_b32 v118, 16, v239
    v_and_b32 v119, 0xffff0000, v239
    v_pk_add_f32 v[104:105], v[96:97], v[240:241] op_sel_hi:[1,0]
    v_pk_add_f32 v[106:107], v[98:99], v[240:241] op_sel_hi:[1,0]
    v_pk_add_f32 v[108:109], v[100:101], v[240:241] op_sel_hi:[1,0]
    v_pk_add_f32 v[110:111], v[102:103], v[240:241] op_sel_hi:[1,0]
    v_cvt_pk_bf16_f32 v120, v104, v105
    v_cvt_pk_bf16_f32 v121, v106, v107
    v_cvt_pk_bf16_f32 v122, v108, v109
    v_cvt_pk_bf16_f32 v123, v110, v111
    v_lshlrev_b32 v104, 16, v120
    v_and_b32 v105, 0xffff0000, v120
    v_lshlrev_b32 v106, 16, v121
    v_and_b32 v107, 0xffff0000, v121
    v_lshlrev_b32 v108, 16, v122
    v_and_b32 v109, 0xffff0000, v122
    v_lshlrev_b32 v110, 16, v123
    v_and_b32 v111, 0xffff0000, v123
    v_pk_mul_f32 v[104:105], v[104:105], v[242:243] op_sel_hi:[1,0]
    v_pk_mul_f32 v[106:107], v[106:107], v[242:243] op_sel_hi:[1,0]
    v_pk_mul_f32 v[108:109], v[108:109], v[242:243] op_sel_hi:[1,0]
    v_pk_mul_f32 v[110:111], v[110:111], v[242:243] op_sel_hi:[1,0]
    v_cvt_pk_bf16_f32 v120, v104, v105
    v_cvt_pk_bf16_f32 v121, v106, v107
    v_cvt_pk_bf16_f32 v122, v108, v109
    v_cvt_pk_bf16_f32 v123, v110, v111
    v_lshlrev_b32 v104, 16, v120
    v_and_b32 v105, 0xffff0000, v120
    v_lshlrev_b32 v106, 16, v121
    v_and_b32 v107, 0xffff0000, v121
    v_lshlrev_b32 v108, 16, v122
    v_and_b32 v109, 0xffff0000, v122
    v_lshlrev_b32 v110, 16, v123
    v_and_b32 v111, 0xffff0000, v123
    v_pk_mul_f32 v[104:105], v[104:105], v[112:113]
    v_pk_mul_f32 v[106:107], v[106:107], v[114:115]
    v_pk_mul_f32 v[108:109], v[108:109], v[116:117]
    v_pk_mul_f32 v[110:111], v[110:111], v[118:119]
    v_cvt_pk_bf16_f32 v236, v104, v105
    v_cvt_pk_bf16_f32 v237, v106, v107
    v_cvt_pk_bf16_f32 v238, v108, v109
    v_cvt_pk_bf16_f32 v239, v110, v111
    s_mov_b32 s63, 0
C_YG:
    s_sleep 4
    ds_read_b32 v248, v246 offset:36
    s_add_u32 s63, s63, 1
    s_waitcnt lgkmcnt(0)
    v_readfirstlane_b32 s62, v248
    s_lshr_b32 s97, s63, 22
    s_lshl_b32 s97, s97, 8
    s_add_u32 s62, s62, s97
    s_cmp_lt_u32 s62, 1
    s_cbranch_scc1 C_YG
    s_mov_b32 s63, 0
C_YP:
    buffer_load_dwordx4 v[64:67], v16, s[12:15], s50 offen sc1
    buffer_load_dwordx4 v[68:71], v16, s[12:15], s51 offen sc1
    buffer_load_dwordx4 v[72:75], v16, s[12:15], s52 offen sc1
    buffer_load_dwordx4 v[76:79], v16, s[12:15], s53 offen sc1
    s_add_u32 s63, s63, 1
    s_waitcnt vmcnt(0)
    v_cmp_ne_u64 vcc, s[76:77], v[66:67]
    v_cmp_ne_u64 s[60:61], s[76:77], v[70:71]
    s_nop 1
    s_or_b64 vcc, vcc, s[60:61]
    v_cmp_ne_u64 s[60:61], s[76:77], v[74:75]
    s_nop 1
    s_or_b64 vcc, vcc, s[60:61]
    v_cmp_ne_u64 s[60:61], s[76:77], v[78:79]
    s_nop 1
    s_or_b64 vcc, vcc, s[60:61]
    s_cmp_gt_u32 s63, 0x10000
    s_cbranch_scc1 C_YX
    s_cmp_eq_u64 vcc, 0
    s_cbranch_scc1 C_YX
    s_sleep 8
    s_branch C_YP
C_YX:
    s_add_u32 s3, s2, s43
    s_cmp_lg_u32 s3, 0
    s_cbranch_scc1 C_NOCLR
    v_mov_b32 v20, 0
    v_mov_b32 v21, 0
    v_mov_b32 v22, 0
    s_mov_b64 exec, 1
    buffer_store_dwordx2 v[20:21], v22, s[92:95], 0 offen sc1
    s_mov_b64 exec, -1
C_NOCLR:
    v_and_b32 v67, 0xffff0000, v65
    v_lshlrev_b32 v66, 16, v65
    v_and_b32 v65, 0xffff0000, v64
    v_lshlrev_b32 v64, 16, v64
    ds_write_b32 v17, v64 offset:0
    ds_write_b32 v17, v65 offset:272
    ds_write_b32 v17, v66 offset:544
    ds_write_b32 v17, v67 offset:816
    v_and_b32 v71, 0xffff0000, v69
    v_lshlrev_b32 v70, 16, v69
    v_and_b32 v69, 0xffff0000, v68
    v_lshlrev_b32 v68, 16, v68
    ds_write_b32 v18, v68 offset:0
    ds_write_b32 v18, v69 offset:272
    ds_write_b32 v18, v70 offset:544
    ds_write_b32 v18, v71 offset:816
    v_and_b32 v75, 0xffff0000, v73
    v_lshlrev_b32 v74, 16, v73
    v_and_b32 v73, 0xffff0000, v72
    v_lshlrev_b32 v72, 16, v72
    ds_write_b32 v17, v72 offset:128
    ds_write_b32 v17, v73 offset:400
    ds_write_b32 v17, v74 offset:672
    ds_write_b32 v17, v75 offset:944
    v_and_b32 v79, 0xffff0000, v77
    v_lshlrev_b32 v78, 16, v77
    v_and_b32 v77, 0xffff0000, v76
    v_lshlrev_b32 v76, 16, v76
    s_waitcnt lgkmcnt(4)
    ds_write_b32 v18, v76 offset:128
    ds_write_b32 v18, v77 offset:400
    ds_write_b32 v18, v78 offset:672
    ds_write_b32 v18, v79 offset:944
KF_FINAL:
    v_lshrrev_b32 v5, 3, v0
    v_and_b32 v6, 7, v0
    v_lshlrev_b32 v7, 10, v5
    v_lshl_add_u32 v7, v6, 4, v7
    v_mul_u32_u24 v8, 272, v5
    v_lshl_add_u32 v9, v6, 5, v8
    v_add_u32 v9, 76800, v9
    v_bfe_u32 v10, v5, 2, 3
    v_lshlrev_b32 v11, 1, v6
    v_xor_b32 v10, v10, v11
    v_xor_b32 v11, 1, v10
    v_lshl_add_u32 v10, v10, 4, v8
    v_lshl_add_u32 v11, v11, 4, v8
    s_mov_b64 s[24:25], s[38:39]
    s_mov_b32 s26, 2097152
    s_mov_b32 s27, 0x00020000
    s_waitcnt vmcnt(0) lgkmcnt(0)
    v_lshlrev_b32 v56, 16, v232
    v_and_b32 v57, 0xffff0000, v232
    v_lshlrev_b32 v58, 16, v233
    v_and_b32 v59, 0xffff0000, v233
    v_lshlrev_b32 v60, 16, v234
    v_and_b32 v61, 0xffff0000, v234
    v_lshlrev_b32 v62, 16, v235
    v_and_b32 v63, 0xffff0000, v235
    v_lshlrev_b32 v64, 16, v236
    v_and_b32 v65, 0xffff0000, v236
    v_lshlrev_b32 v66, 16, v237
    v_and_b32 v67, 0xffff0000, v237
    v_lshlrev_b32 v68, 16, v238
    v_and_b32 v69, 0xffff0000, v238
    v_lshlrev_b32 v70, 16, v239
    v_and_b32 v71, 0xffff0000, v239
    s_barrier
    ds_read_b128 v[16:19], v9 offset:0
    ds_read_b128 v[20:23], v9 offset:16
    ds_read_b128 v[24:27], v9 offset:17408
    ds_read_b128 v[28:31], v9 offset:17424
    ds_read_b128 v[32:35], v9 offset:34816
    ds_read_b128 v[36:39], v9 offset:34832
    ds_read_b128 v[40:43], v9 offset:52224
    ds_read_b128 v[44:47], v9 offset:52240
    ds_read_b128 v[48:51], v10 offset:0
    ds_read_b128 v[52:55], v11 offset:0
    s_waitcnt lgkmcnt(0)
    v_pk_add_f32 v[16:17], v[16:17], v[24:25]
    v_pk_add_f32 v[32:33], v[32:33], v[40:41]
    v_pk_add_f32 v[18:19], v[18:19], v[26:27]
    v_pk_add_f32 v[34:35], v[34:35], v[42:43]
    v_pk_add_f32 v[20:21], v[20:21], v[28:29]
    v_pk_add_f32 v[36:37], v[36:37], v[44:45]
    v_pk_add_f32 v[22:23], v[22:23], v[30:31]
    v_pk_add_f32 v[38:39], v[38:39], v[46:47]
    v_pk_add_f32 v[16:17], v[16:17], v[32:33]
    v_pk_add_f32 v[48:49], v[48:49], v[64:65]
    v_pk_add_f32 v[18:19], v[18:19], v[34:35]
    v_pk_add_f32 v[50:51], v[50:51], v[66:67]
    v_pk_add_f32 v[20:21], v[20:21], v[36:37]
    v_pk_add_f32 v[52:53], v[52:53], v[68:69]
    v_pk_add_f32 v[22:23], v[22:23], v[38:39]
    v_pk_add_f32 v[54:55], v[54:55], v[70:71]
    v_cvt_pk_bf16_f32 v80, v16, v17
    v_cvt_pk_bf16_f32 v81, v18, v19
    v_cvt_pk_bf16_f32 v82, v20, v21
    v_cvt_pk_bf16_f32 v83, v22, v23
    v_lshlrev_b32 v16, 16, v80
    v_and_b32 v17, 0xffff0000, v80
    v_lshlrev_b32 v18, 16, v81
    v_and_b32 v19, 0xffff0000, v81
    v_lshlrev_b32 v20, 16, v82
    v_and_b32 v21, 0xffff0000, v82
    v_lshlrev_b32 v22, 16, v83
    v_and_b32 v23, 0xffff0000, v83
    v_cvt_pk_bf16_f32 v80, v48, v49
    v_cvt_pk_bf16_f32 v81, v50, v51
    v_cvt_pk_bf16_f32 v82, v52, v53
    v_cvt_pk_bf16_f32 v83, v54, v55
    v_lshlrev_b32 v48, 16, v80
    v_and_b32 v49, 0xffff0000, v80
    v_lshlrev_b32 v50, 16, v81
    v_and_b32 v51, 0xffff0000, v81
    v_lshlrev_b32 v52, 16, v82
    v_and_b32 v53, 0xffff0000, v82
    v_lshlrev_b32 v54, 16, v83
    v_and_b32 v55, 0xffff0000, v83
    v_pk_add_f32 v[48:49], v[48:49], v[56:57]
    v_pk_add_f32 v[50:51], v[50:51], v[58:59]
    v_pk_add_f32 v[52:53], v[52:53], v[60:61]
    v_pk_add_f32 v[54:55], v[54:55], v[62:63]
    v_cvt_pk_bf16_f32 v80, v48, v49
    v_cvt_pk_bf16_f32 v81, v50, v51
    v_cvt_pk_bf16_f32 v82, v52, v53
    v_cvt_pk_bf16_f32 v83, v54, v55
    v_lshlrev_b32 v48, 16, v80
    v_and_b32 v49, 0xffff0000, v80
    v_lshlrev_b32 v50, 16, v81
    v_and_b32 v51, 0xffff0000, v81
    v_lshlrev_b32 v52, 16, v82
    v_and_b32 v53, 0xffff0000, v82
    v_lshlrev_b32 v54, 16, v83
    v_and_b32 v55, 0xffff0000, v83
    v_pk_add_f32 v[48:49], v[48:49], v[16:17]
    v_pk_add_f32 v[50:51], v[50:51], v[18:19]
    v_pk_add_f32 v[52:53], v[52:53], v[20:21]
    v_pk_add_f32 v[54:55], v[54:55], v[22:23]
    v_cvt_pk_bf16_f32 v80, v48, v49
    v_cvt_pk_bf16_f32 v81, v50, v51
    v_cvt_pk_bf16_f32 v82, v52, v53
    v_cvt_pk_bf16_f32 v83, v54, v55
    buffer_store_dwordx4 v[80:83], v7, s[24:27], s44 offen sc1
KF_END:
    s_endpgm
.section .rodata,"a"
.p2align 6
.amdhsa_kernel parallel_sum__ssm_conv_s4d__glu_gated_reglu__prompt_kernel
  .amdhsa_next_free_vgpr 252
  .amdhsa_next_free_sgpr 102
  .amdhsa_accum_offset 252
  .amdhsa_group_segment_fixed_size 0
  .amdhsa_kernarg_size 112
  .amdhsa_user_sgpr_count 2
  .amdhsa_user_sgpr_kernarg_segment_ptr 1
  .amdhsa_system_sgpr_workgroup_id_x 1
.end_amdhsa_kernel
```
